```python
import torch

def _softmax(x, axis=-1):
    return torch.softmax(x, dim=axis)
def _gelu(x):
    return torch.nn.functional.gelu(x, approximate="tanh")
def _silu(x):
    return torch.nn.functional.silu(x)
def _sigmoid(x):
    return torch.sigmoid(x)
def _layernorm(x, axis=-1, eps=1e-5):
    m = x.mean(dim=axis, keepdim=True)
    v = x.var(dim=axis, keepdim=True, unbiased=False)
    return (x - m) / torch.sqrt(v + eps)
def _scatter_add(tgt, idx, src, axis=0):
    return tgt.clone().index_add_(axis, idx, src)
def _segment_sum(src, seg, n):
    out = torch.zeros((n,) + src.shape[1:], dtype=src.dtype)
    return out.index_add_(0, seg, src)
def _pad(x, pw):
    flat = tuple(v for pair in reversed(pw) for v in pair)
    return torch.nn.functional.pad(x, flat)

kernel_name = 'interleave_layers__linear_attn_block__softmax_full_mha__prompt'

def setup_inputs():

    _w = (lambda a: (lambda t: t.to(torch.bfloat16) if t.is_floating_point() else t)(torch.as_tensor(a)))
    def _A_setup():
        B, S, D = 1, 2048, 640
        return {
            "x": _w((lambda *s: torch.randn(*s, dtype=torch.bfloat16) * 0.05)(B, S, D)),
            "wqkv": _w((lambda *s: torch.randn(*s, dtype=torch.bfloat16) * 0.05)(D, 3 * D)),
            "wo": _w((lambda *s: torch.randn(*s, dtype=torch.bfloat16) * 0.05)(D, D)),
        }
    _A_in = _A_setup()

    def _B_setup():
        B, S, D = 1, 2048, 640
        return {
            "x": _w((lambda *s: torch.randn(*s, dtype=torch.bfloat16) * 0.05)(B, S, D)),
            "wqkv": _w((lambda *s: torch.randn(*s, dtype=torch.bfloat16) * 0.1)(D, 3 * D)),
            "wo": _w((lambda *s: torch.randn(*s, dtype=torch.bfloat16) * 0.05)(D, D)),
        }
    _B_in = _B_setup()

    return {
        "A_x": _A_in["x"],
        "A_wqkv": _A_in["wqkv"],
        "A_wo": _A_in["wo"],
        "B_x": _B_in["x"],
        "B_wqkv": _B_in["wqkv"],
        "B_wo": _B_in["wo"],
    }

def reference(A_x, A_wqkv, A_wo, B_x, B_wqkv, B_wo):
    def _A_ref(x, wqkv, wo):
        B, S, D = x.shape
        H = 32; Dh = D // H
        qkv = (lambda x, *d: x.permute(*d))((x @ wqkv).reshape(B, S, 3, H, Dh), 2, 0, 3, 1, 4)
        q, k, v = qkv[0], qkv[1], qkv[2]
        phi = lambda t: torch.where(t > 0, t + 1, torch.exp(t)) + 1e-6
        pq, pk = phi(q), phi(k)
        kv = torch.einsum("bhsd,bhse->bhde", pk, v)
        z = torch.einsum("bhsd->bhd", pk)
        num = torch.einsum("bhqd,bhde->bhqe", pq, kv)
        den = torch.einsum("bhqd,bhd->bhq", pq, z)[..., None] + 1e-6
        o = num / den
        return (lambda x, *d: x.permute(*d))(o, 0, 2, 1, 3).reshape(B, S, D) @ wo

    def _B_ref(x, wqkv, wo):
        B, S, D = x.shape
        H = 32; Dh = D // H
        qkv = (lambda x, *d: x.permute(*d))((x @ wqkv).reshape(B, S, 3, H, Dh), 2, 0, 3, 1, 4)
        q, k, v = qkv[0], qkv[1], qkv[2]
        scale = Dh ** -0.5
        scores = torch.einsum("bhqd,bhkd->bhqk", q, k) * scale
        p = _softmax(scores, axis=-1)
        o = torch.einsum("bhqk,bhkd->bhqd", p, v)
        return (lambda x, *d: x.permute(*d))(o, 0, 2, 1, 3).reshape(B, S, D) @ wo

    x = A_x
    x = x + _A_ref(_layernorm(x, axis=-1), A_wqkv, A_wo)
    x = x + _B_ref(_layernorm(x, axis=-1), B_wqkv, B_wo)
    x = x + _A_ref(_layernorm(x, axis=-1), A_wqkv, A_wo)
    x = x + _B_ref(_layernorm(x, axis=-1), B_wqkv, B_wo)
    return x
```

```asm
; @launch kernel=interleave_layers__linear_attn_block__softmax_full_mha__prompt_kernel grid=(256,1,1) block=(256,1,1) lds=163840
.amdgcn_target "amdgcn-amd-amdhsa--gfx950"
.text
.globl interleave_layers__linear_attn_block__softmax_full_mha__prompt_kernel
.p2align 8
.type interleave_layers__linear_attn_block__softmax_full_mha__prompt_kernel,@function
interleave_layers__linear_attn_block__softmax_full_mha__prompt_kernel:
    s_cmp_ge_u32 s2, 256
    s_cbranch_scc1 L_m_end
    s_load_dwordx16 s[36:51], s[0:1], 0
    s_load_dwordx2 s[4:5], s[0:1], 64
    s_getpc_b64 s[52:53]
L_m_pc:
    s_lshr_b32 s6, s2, 3
    s_mul_i32 s6, s6, 1024
    v_and_b32 v1, 7, v0
    v_lshl_add_u32 v1, v1, 7, s6
    v_min_u32 v1, L_m_last-L_m_pc-4, v1
    v_mov_b32 v3, s53
    v_add_co_u32 v2, vcc, s52, v1
    s_nop 1
    v_addc_co_u32 v3, vcc, 0, v3, vcc
    global_load_dword v62, v[2:3], off
    v_lshrrev_b32 v1, 6, v0
    v_and_b32 v252, 63, v0
    v_readfirstlane_b32 s3, v1
    v_lshlrev_b32_e64 v253, 4, v252
    s_mov_b32 s96, 1
    s_mov_b32 s97, 0
    s_lshr_b32 s18, s2, 5
    s_lshl_b32 s18, s18, 3
    s_and_b32 s19, s2, 7
    s_add_u32 s18, s18, s19
    s_lshl_b32 s18, s18, 2
    s_bfe_u32 s19, s2, 0x20003
    s_add_u32 s18, s18, s19
    s_mul_i32 s16, s3, 7168
    v_lshrrev_b32 v7, 1, v252
    v_mul_u32_u24 v7, 3840, v7
    v_and_b32_e64 v5, 1, v252
    v_lshl_add_u32 v7, v5, 4, v7
    s_cmp_ge_u32 s18, 120
    s_cselect_b32 s31, 120, 0
    s_cselect_b32 s30, 0x280000, 0
    s_cselect_b32 s33, 0x3ea52b5c, 1.0
    s_sub_u32 s31, s18, s31
    s_lshl_b32 s34, s31, 5
    s_mul_i32 s17, s3, 614400
    s_add_u32 s34, s34, s17
    s_cmp_ge_u32 s18, 240
    s_cselect_b32 s26, 0, 2457600
    s_mov_b32 s27, 0x20000
    s_mov_b32 m0, s16
    v_lshrrev_b32_e64 v2, 5, v252
    v_bfe_u32 v3, v252, 4, 1
    v_bfe_u32 v4, v252, 2, 2
    v_and_b32_e64 v5, 3, v252
    s_mul_i32 s61, s2, 205
    s_lshr_b32 s61, s61, 11
    s_mul_i32 s63, s61, 10
    s_sub_u32 s63, s2, s63
    s_lshl_b32 s63, s63, 1
    s_lshr_b32 s62, s3, 1
    s_add_u32 s63, s63, s62
    s_cmp_ge_u32 s61, 10
    s_cselect_b32 s62, 10, 0
    s_sub_u32 s62, s61, s62
    s_lshl_b32 s62, s62, 1
    s_and_b32 s60, s3, 1
    s_add_u32 s62, s62, s60
    v_lshlrev_b32_e64 v8, 3, v3
    v_lshl_add_u32 v8, v2, 2, v8
    v_mul_u32_u24_e64 v9, 40, v2
    v_mad_u32_u24 v9, v3, 20, v9
    v_add_u32_e64 v9, 16, v9
    s_mul_i32 s20, s63, 51200
    s_mul_i32 s21, s63, 204800
    s_sub_u32 s21, s21, 3276800
    s_cmp_lt_u32 s63, 16
    s_cselect_b32 s20, s20, s21
    s_cselect_b64 vcc, -1, 0
    s_cselect_b32 s21, 20, 80
    v_cndmask_b32 v8, v9, v8, vcc
    v_add_u32_e64 v8, v8, v4
    v_mul_u32_u24 v8, 1280, v8
    v_lshl_add_u32 v8, v5, 4, v8
    s_lshl_b32 s22, s62, 6
    s_add_u32 s20, s20, s22
    s_mul_i32 s21, s21, 1280
    s_add_u32 s21, s21, s20
    s_cmp_ge_u32 s18, 120
    s_waitcnt lgkmcnt(0)
    s_cselect_b32 s24, s44, s38
    s_cselect_b32 s25, s45, s39
    s_add_u32 s52, s4, 0x7f7f80
    s_addc_u32 s53, s5, 0
    s_load_dwordx2 s[100:101], s[52:53], 0
    s_mov_b32 s54, s34
    s_cmp_ge_u32 s61, 10
    s_cselect_b32 s12, s46, s40
    s_cselect_b32 s13, s47, s41
    s_cselect_b32 s28, 0xc8000, 0
    s_cmp_ge_u32 s2, 200
    s_cselect_b32 s14, 0, 819200
    s_mov_b32 s15, 0x20000
    s_add_u32 m0, s16, 5120
    s_sub_u32 s21, s21, 1024
    buffer_load_dwordx4 v8, s[12:15], s20 offen lds
    buffer_load_dwordx4 v8, s[12:15], s21 offen offset:1024 lds
    s_bfe_u32 s6, s2, 0x30003
    s_and_b32 s7, s2, 7
    s_lshl_b32 s7, s7, 2
    s_lshr_b32 s17, s2, 6
    s_add_u32 s7, s7, s17
    s_mov_b32 s8, s36
    s_mov_b32 s9, s37
    s_mov_b32 s10, 0x280000
    s_mov_b32 s11, 0x20000
    s_and_b32 s34, s3, 1
    s_lshr_b32 s35, s3, 1
    s_lshl_b32 s17, s7, 1
    s_add_u32 s17, s17, s34
    s_mul_i32 s19, s17, 40960
    s_mul_i32 s20, s6, 160
    s_add_u32 s19, s19, s20
    s_lshl_b32 s20, s35, 6
    s_add_u32 s20, s20, s19
    v_and_b32_e64 v1, 31, v252
    v_mul_u32_u24 v9, 1280, v1
    v_lshl_add_u32 v9, v2, 4, v9
    buffer_load_dwordx4 v[240:243], v9, s[8:11], s20 offen
    buffer_load_dwordx4 v[244:247], v9, s[8:11], s20 offen offset:32
    buffer_load_dwordx4 v[248:251], v9, s[8:11], s19 offen offset:128
    s_mov_b32 m0, s16
    s_nop 0
    buffer_load_dwordx4 v7, s[24:27], s54 offen offset:0 lds
    s_add_u32 s54, s54, 121856
    buffer_load_dwordx4 v7, s[24:27], s54 offen offset:1024 lds
    s_add_u32 s54, s54, 121856
    buffer_load_dwordx4 v7, s[24:27], s54 offen offset:2048 lds
    s_add_u32 s54, s54, 121856
    buffer_load_dwordx4 v7, s[24:27], s54 offen offset:3072 lds
    s_add_u32 s54, s54, 125952
    s_add_u32 m0, s16, 4096
    s_nop 0
    buffer_load_dwordx4 v7, s[24:27], s54 offen offset:0 lds
    s_mov_b32 s56, s4
    s_mov_b32 s57, s5
    s_mov_b32 s58, 0x2b78000
    s_mov_b32 s59, 0x20000
    s_mov_b64 s[98:99], s[48:49]
    v_mov_b32 v56, -1
    v_mov_b32 v57, -1
    v_mov_b32 v58, -1
    v_mov_b32 v59, -1
    v_lshl_add_u32 v9, s2, 8, v0
    v_lshlrev_b32_e64 v9, 4, v9
    v_cmp_gt_u32 vcc, 0x14000, v9
    v_mov_b32_e64 v10, 0x40000000
    s_nop 0
    v_cndmask_b32 v9, v10, v9, vcc
    s_mov_b32 s19, 0x790000
    buffer_store_dwordx4 v[56:59], v9, s[56:59], s19 offen sc1
    s_lshl_b32 s19, s62, 5
    v_add_u32 v8, s19, v1
    v_mul_u32_u24 v9, 0xcd, v8
    v_lshrrev_b32_e64 v9, 14, v9
    v_mul_u32_u24 v10, 80, v9
    v_sub_u32_e64 v10, v8, v10
    v_mul_u32_u24 v14, 0x19000, v9
    v_lshl_add_u32 v14, v2, 9, v14
    v_lshl_add_u32 v14, v5, 4, v14
    v_bfe_u32 v13, v10, 3, 1
    v_lshl_add_u32 v14, v13, 6, v14
    v_bfe_u32 v13, v10, 2, 1
    v_lshl_add_u32 v14, v13, 7, v14
    v_bfe_u32 v13, v10, 4, 1
    v_lshl_add_u32 v14, v13, 8, v14
    v_bfe_u32 v13, v10, 5, 1
    v_lshl_add_u32 v14, v13, 10, v14
    v_bfe_u32 v13, v10, 6, 1
    v_lshl_add_u32 v14, v13, 12, v14
    v_mul_u32_u24 v13, 1792, v13
    v_sub_u32 v13, 2048, v13
    v_add_u32_e64 v15, v13, v14
    s_mul_i32 s29, s63, 5120
    s_add_u32 s28, s28, s29
    s_add_u32 s28, s28, 0x500000
    s_cmp_ge_u32 s2, 200
    s_cselect_b32 s29, 0x40000000, 0
    v_add_u32 v14, s29, v14
    v_add_u32 v15, s29, v15
    v_lshlrev_b32_e64 v6, 9, v2
    v_lshl_add_u32 v6, v4, 6, v6
    v_lshl_add_u32 v6, v3, 5, v6
    v_lshl_add_u32 v6, v5, 3, v6
    v_add_u32_e64 v6, s16, v6
    s_mul_i32 s19, s17, 43008
    s_add_u32 s19, s19, 0x7f8000
    s_mul_i32 s20, s6, 5120
    s_add_u32 s20, s20, s19
    s_lshl_b32 s21, s35, 11
    s_add_u32 s21, s21, s20
    s_add_u32 s20, s20, 4096
    s_lshl_b32 s22, s6, 1
    s_add_u32 s22, s22, s35
    s_lshl_b32 s22, s22, 7
    s_add_u32 s22, s22, s19
    s_add_u32 s22, s22, 40960
    s_lshl_b32 s23, s35, 30
    v_add_u32 v60, s23, v253
    v_lshlrev_b32 v61, 2, v1
    s_cmp_eq_u32 s35, 0
    s_cselect_b32 s23, 1.0, 0
    s_cmp_ge_u32 s18, 240
    s_cbranch_scc1 L_m_ppad
    s_mul_i32 s35, s31, 103
    s_lshr_b32 s35, s35, 12
    s_cmp_eq_u32 s35, 0
    s_cselect_b32 s33, s33, 1.0
    s_mul_i32 s32, s35, 40
    s_sub_u32 s32, s31, s32
    s_lshl_b32 s32, s32, 4
    s_mul_i32 s35, s35, 5
    v_and_b32 v7, 15, v252
    v_add_u32 v8, s32, v7
    v_mul_u32_u24 v9, 0xcd, v8
    v_lshrrev_b32 v9, 12, v9
    v_mul_u32_u24 v10, 20, v9
    v_sub_u32 v10, v8, v10
    v_lshrrev_b32 v11, 2, v10
    v_add_u32 v11, s35, v11
    v_lshrrev_b32 v12, 1, v9
    v_mul_u32_u24 v12, 0x28000, v12
    v_lshrrev_b32_e64 v13, 2, v11
    v_lshl_add_u32 v12, v13, 10, v12
    v_and_b32_e64 v13, 3, v11
    v_lshl_add_u32 v12, v13, 7, v12
    v_and_b32_e64 v13, 1, v9
    v_lshl_add_u32 v12, v13, 6, v12
    v_lshl_add_u32 v12, v5, 4, v12
    v_lshl_add_u32 v12, v3, 9, v12
    v_lshl_add_u32 v12, v2, 12, v12
    s_cmp_ge_u32 s18, 999
    s_cselect_b32 s32, 0x40000000, 0
    v_add_u32 v12, s32, v12
    s_mul_i32 s32, s3, 40960
    s_add_u32 s30, s30, s32
    v_lshrrev_b32 v8, 4, v252
    v_lshlrev_b32_e64 v8, 8, v8
    v_lshl_add_u32 v8, v7, 3, v8
    v_add_u32 v8, s16, v8
    v_lshlrev_b32 v9, 4, v7
    s_lshl_b32 s32, s3, 2
    v_add_u32 v10, s32, v9
    s_mov_b32 s32, 0x3f803f80
    s_waitcnt vmcnt(1) lgkmcnt(0)
    ds_read_b64_tr_b16 v[16:17], v8 offset:0
    ds_read_b64_tr_b16 v[18:19], v8 offset:128
    ds_read_b64_tr_b16 v[20:21], v8 offset:1024
    ds_read_b64_tr_b16 v[22:23], v8 offset:1152
    ds_read_b64_tr_b16 v[24:25], v8 offset:2048
    ds_read_b64_tr_b16 v[26:27], v8 offset:2176
    ds_read_b64_tr_b16 v[28:29], v8 offset:3072
    ds_read_b64_tr_b16 v[30:31], v8 offset:3200
    ds_read_b64_tr_b16 v[32:33], v8 offset:4096
    ds_read_b64_tr_b16 v[34:35], v8 offset:4224
    s_waitcnt lgkmcnt(8)
    v_dot2_f32_bf16 v36, v16, s32, 0
    v_dot2_f32_bf16 v37, v17, s32, 0
    v_dot2_f32_bf16 v38, v18, s32, 0
    v_dot2_f32_bf16 v39, v19, s32, 0
    s_waitcnt lgkmcnt(6)
    v_dot2_f32_bf16 v36, v20, s32, v36
    v_dot2_f32_bf16 v37, v21, s32, v37
    v_dot2_f32_bf16 v38, v22, s32, v38
    v_dot2_f32_bf16 v39, v23, s32, v39
    s_waitcnt lgkmcnt(4)
    v_dot2_f32_bf16 v36, v24, s32, v36
    v_dot2_f32_bf16 v37, v25, s32, v37
    v_dot2_f32_bf16 v38, v26, s32, v38
    v_dot2_f32_bf16 v39, v27, s32, v39
    s_waitcnt lgkmcnt(2)
    v_dot2_f32_bf16 v36, v28, s32, v36
    v_dot2_f32_bf16 v37, v29, s32, v37
    v_dot2_f32_bf16 v38, v30, s32, v38
    v_dot2_f32_bf16 v39, v31, s32, v39
    s_waitcnt lgkmcnt(0)
    v_dot2_f32_bf16 v36, v32, s32, v36
    v_dot2_f32_bf16 v37, v33, s32, v37
    v_dot2_f32_bf16 v38, v34, s32, v38
    v_dot2_f32_bf16 v39, v35, s32, v39
    s_nop 0
    v_add_f32 v36, v36, v37
    s_nop 0
    v_add_f32 v38, v38, v39
    v_add_f32 v36, v36, v38
    v_mov_b32 v37, v36
    s_nop 1
    v_permlane32_swap_b32 v36, v37
    v_add_f32 v36, v36, v37
    v_mov_b32 v37, v36
    s_nop 1
    v_permlane16_swap_b32 v36, v37
    v_add_f32_e64 v36, v36, v37
    ds_write_b32 v10, v36 offset:28672
    s_waitcnt lgkmcnt(0)
    s_barrier
    ds_read_b128 v[36:39], v9 offset:28672
    v_mov_b32 v48, s33
    s_waitcnt lgkmcnt(0)
    v_add_f32 v36, v36, v37
    v_add_f32 v38, v38, v39
    v_add_f32_e64 v36, v36, v38
    v_mul_f32 v36, 0xbacccccd, v36
    v_mul_f32 v36, s33, v36
    v_lshlrev_b32 v64, 16, v16
    v_and_b32 v65, 0xffff0000, v16
    v_lshlrev_b32_e64 v66, 16, v17
    v_and_b32 v67, 0xffff0000, v17
    v_lshlrev_b32_e64 v68, 16, v18
    v_and_b32 v69, 0xffff0000, v18
    v_lshlrev_b32_e64 v70, 16, v19
    v_and_b32 v71, 0xffff0000, v19
    v_pk_fma_f32 v[64:65], v[64:65], v[48:49], v[36:37] op_sel_hi:[1,0,0]
    v_pk_fma_f32 v[66:67], v[66:67], v[48:49], v[36:37] op_sel_hi:[1,0,0]
    v_pk_fma_f32 v[68:69], v[68:69], v[48:49], v[36:37] op_sel_hi:[1,0,0]
    v_pk_fma_f32 v[70:71], v[70:71], v[48:49], v[36:37] op_sel_hi:[1,0,0]
    v_cvt_pk_bf16_f32 v16, v64, v65
    v_cvt_pk_bf16_f32 v17, v66, v67
    v_cvt_pk_bf16_f32 v18, v68, v69
    v_cvt_pk_bf16_f32 v19, v70, v71
    buffer_store_dwordx4 v[16:19], v12, s[56:59], s30 offen sc1
    s_add_u32 s30, s30, 8192
    v_lshlrev_b32_e64 v64, 16, v20
    v_and_b32 v65, 0xffff0000, v20
    v_lshlrev_b32_e64 v66, 16, v21
    v_and_b32 v67, 0xffff0000, v21
    v_lshlrev_b32_e64 v68, 16, v22
    v_and_b32 v69, 0xffff0000, v22
    v_lshlrev_b32_e64 v70, 16, v23
    v_and_b32 v71, 0xffff0000, v23
    v_pk_fma_f32 v[64:65], v[64:65], v[48:49], v[36:37] op_sel_hi:[1,0,0]
    v_pk_fma_f32 v[66:67], v[66:67], v[48:49], v[36:37] op_sel_hi:[1,0,0]
    v_pk_fma_f32 v[68:69], v[68:69], v[48:49], v[36:37] op_sel_hi:[1,0,0]
    v_pk_fma_f32 v[70:71], v[70:71], v[48:49], v[36:37] op_sel_hi:[1,0,0]
    v_cvt_pk_bf16_f32 v20, v64, v65
    v_cvt_pk_bf16_f32 v21, v66, v67
    v_cvt_pk_bf16_f32 v22, v68, v69
    v_cvt_pk_bf16_f32 v23, v70, v71
    buffer_store_dwordx4 v[20:23], v12, s[56:59], s30 offen sc1
    s_add_u32 s30, s30, 8192
    v_lshlrev_b32_e64 v64, 16, v24
    v_and_b32 v65, 0xffff0000, v24
    v_lshlrev_b32_e64 v66, 16, v25
    v_and_b32 v67, 0xffff0000, v25
    v_lshlrev_b32_e64 v68, 16, v26
    v_and_b32 v69, 0xffff0000, v26
    v_lshlrev_b32_e64 v70, 16, v27
    v_and_b32 v71, 0xffff0000, v27
    v_pk_fma_f32 v[64:65], v[64:65], v[48:49], v[36:37] op_sel_hi:[1,0,0]
    v_pk_fma_f32 v[66:67], v[66:67], v[48:49], v[36:37] op_sel_hi:[1,0,0]
    v_pk_fma_f32 v[68:69], v[68:69], v[48:49], v[36:37] op_sel_hi:[1,0,0]
    v_pk_fma_f32 v[70:71], v[70:71], v[48:49], v[36:37] op_sel_hi:[1,0,0]
    v_cvt_pk_bf16_f32 v24, v64, v65
    v_cvt_pk_bf16_f32 v25, v66, v67
    v_cvt_pk_bf16_f32 v26, v68, v69
    v_cvt_pk_bf16_f32 v27, v70, v71
    buffer_store_dwordx4 v[24:27], v12, s[56:59], s30 offen sc1
    s_add_u32 s30, s30, 8192
    v_lshlrev_b32_e64 v64, 16, v28
    v_and_b32 v65, 0xffff0000, v28
    v_lshlrev_b32_e64 v66, 16, v29
    v_and_b32 v67, 0xffff0000, v29
    v_lshlrev_b32_e64 v68, 16, v30
    v_and_b32 v69, 0xffff0000, v30
    v_lshlrev_b32_e64 v70, 16, v31
    v_and_b32 v71, 0xffff0000, v31
    v_pk_fma_f32 v[64:65], v[64:65], v[48:49], v[36:37] op_sel_hi:[1,0,0]
    v_pk_fma_f32 v[66:67], v[66:67], v[48:49], v[36:37] op_sel_hi:[1,0,0]
    v_pk_fma_f32 v[68:69], v[68:69], v[48:49], v[36:37] op_sel_hi:[1,0,0]
    v_pk_fma_f32 v[70:71], v[70:71], v[48:49], v[36:37] op_sel_hi:[1,0,0]
    v_cvt_pk_bf16_f32 v28, v64, v65
    v_cvt_pk_bf16_f32 v29, v66, v67
    v_cvt_pk_bf16_f32 v30, v68, v69
    v_cvt_pk_bf16_f32 v31, v70, v71
    buffer_store_dwordx4 v[28:31], v12, s[56:59], s30 offen sc1
    s_add_u32 s30, s30, 8192
    v_lshlrev_b32_e64 v64, 16, v32
    v_and_b32 v65, 0xffff0000, v32
    v_lshlrev_b32_e64 v66, 16, v33
    v_and_b32 v67, 0xffff0000, v33
    v_lshlrev_b32_e64 v68, 16, v34
    v_and_b32 v69, 0xffff0000, v34
    v_lshlrev_b32_e64 v70, 16, v35
    v_and_b32 v71, 0xffff0000, v35
    v_pk_fma_f32 v[64:65], v[64:65], v[48:49], v[36:37] op_sel_hi:[1,0,0]
    v_pk_fma_f32 v[66:67], v[66:67], v[48:49], v[36:37] op_sel_hi:[1,0,0]
    v_pk_fma_f32 v[68:69], v[68:69], v[48:49], v[36:37] op_sel_hi:[1,0,0]
    v_pk_fma_f32 v[70:71], v[70:71], v[48:49], v[36:37] op_sel_hi:[1,0,0]
    v_cvt_pk_bf16_f32 v32, v64, v65
    v_cvt_pk_bf16_f32 v33, v66, v67
    v_cvt_pk_bf16_f32 v34, v68, v69
    v_cvt_pk_bf16_f32 v35, v70, v71
    buffer_store_dwordx4 v[32:35], v12, s[56:59], s30 offen sc1
    s_branch L_m_prest
L_m_ppad:
    s_sub_u32 s30, s18, 240
    s_lshl_b32 s30, s30, 2
    s_add_u32 s30, s30, s3
    s_lshl_b32 s31, s30, 14
    s_add_u32 s31, s31, 0x690000
    s_mul_i32 s30, s30, 81920
    v_lshrrev_b32 v8, 4, v252
    v_lshlrev_b32 v8, 12, v8
    v_bfe_u32 v9, v252, 3, 1
    v_lshl_add_u32 v8, v9, 9, v8
    v_and_b32_e64 v9, 7, v252
    v_lshl_add_u32 v8, v9, 4, v8
    v_mov_b32 v16, 0x3f803f80
    v_mov_b32 v17, 0x3f803f80
    v_mov_b32 v18, 0x3f803f80
    v_mov_b32 v19, 0x3f803f80
    buffer_store_dwordx4 v[56:59], v253, s[56:59], s31 offen offset:0 sc1
    buffer_store_dwordx4 v[56:59], v253, s[56:59], s31 offen offset:1024 sc1
    buffer_store_dwordx4 v[56:59], v253, s[56:59], s31 offen offset:2048 sc1
    buffer_store_dwordx4 v[56:59], v253, s[56:59], s31 offen offset:3072 sc1
    s_add_u32 s31, s31, 4096
    buffer_store_dwordx4 v[56:59], v253, s[56:59], s31 offen offset:0 sc1
    buffer_store_dwordx4 v[56:59], v253, s[56:59], s31 offen offset:1024 sc1
    buffer_store_dwordx4 v[56:59], v253, s[56:59], s31 offen offset:2048 sc1
    buffer_store_dwordx4 v[56:59], v253, s[56:59], s31 offen offset:3072 sc1
    s_add_u32 s31, s31, 4096
    buffer_store_dwordx4 v[56:59], v253, s[56:59], s31 offen offset:0 sc1
    buffer_store_dwordx4 v[56:59], v253, s[56:59], s31 offen offset:1024 sc1
    buffer_store_dwordx4 v[56:59], v253, s[56:59], s31 offen offset:2048 sc1
    buffer_store_dwordx4 v[56:59], v253, s[56:59], s31 offen offset:3072 sc1
    s_add_u32 s31, s31, 4096
    buffer_store_dwordx4 v[56:59], v253, s[56:59], s31 offen offset:0 sc1
    buffer_store_dwordx4 v[56:59], v253, s[56:59], s31 offen offset:1024 sc1
    buffer_store_dwordx4 v[56:59], v253, s[56:59], s31 offen offset:2048 sc1
    buffer_store_dwordx4 v[56:59], v253, s[56:59], s31 offen offset:3072 sc1
    s_add_u32 s31, s31, 4096
    buffer_store_dwordx4 v[16:19], v8, s[56:59], s30 offen offset:3456 sc1
    s_add_u32 s30, s30, 16384
    buffer_store_dwordx4 v[16:19], v8, s[56:59], s30 offen offset:3456 sc1
    s_add_u32 s30, s30, 16384
    buffer_store_dwordx4 v[16:19], v8, s[56:59], s30 offen offset:3456 sc1
    s_add_u32 s30, s30, 16384
    buffer_store_dwordx4 v[16:19], v8, s[56:59], s30 offen offset:3456 sc1
    s_add_u32 s30, s30, 16384
    buffer_store_dwordx4 v[16:19], v8, s[56:59], s30 offen offset:3456 sc1
L_m_prest:
    s_waitcnt vmcnt(6)
    ds_read_b64_tr_b16 v[40:41], v6 offset:5120
    ds_read_b64_tr_b16 v[42:43], v6 offset:5376
    ds_read_b64_tr_b16 v[44:45], v6 offset:6144
    ds_read_b64_tr_b16 v[46:47], v6 offset:6400
    buffer_store_dwordx4 v[240:243], v253, s[56:59], s21 offen sc1
    buffer_store_dwordx4 v[244:247], v253, s[56:59], s21 offen offset:1024 sc1
    buffer_store_dwordx4 v[248:251], v60, s[56:59], s20 offen sc1
    s_waitcnt lgkmcnt(0)
    buffer_store_dwordx4 v[40:43], v14, s[56:59], s28 offen sc1
    buffer_store_dwordx4 v[44:47], v15, s[56:59], s28 offen sc1
    v_dot2_f32_bf16 v64, v240, v240, 0
    v_dot2_f32_bf16 v65, v244, v244, 0
    v_dot2_f32_bf16 v66, v248, v248, 0
    v_dot2_f32_bf16 v64, v241, v241, v64
    v_dot2_f32_bf16 v65, v245, v245, v65
    v_dot2_f32_bf16 v66, v249, v249, v66
    v_dot2_f32_bf16 v64, v242, v242, v64
    v_dot2_f32_bf16 v65, v246, v246, v65
    v_dot2_f32_bf16 v66, v250, v250, v66
    v_dot2_f32_bf16 v64, v243, v243, v64
    v_dot2_f32_bf16 v65, v247, v247, v65
    v_dot2_f32_bf16 v66, v251, v251, v66
    s_nop 1
    v_add_f32 v64, v64, v65
    v_fma_f32 v64, v66, s23, v64
    v_mov_b32 v65, v64
    s_nop 1
    v_permlane32_swap_b32 v65, v64
    v_add_f32 v64, v64, v65
    buffer_store_dword v64, v61, s[56:59], s22 offen sc1
    v_and_b32 v1, 31, v252
    v_cmp_eq_u32 vcc, 20, v1
    v_mov_b32 v1, 0x3f803f80
    s_nop 0
    v_cndmask_b32 v1, 0, v1, vcc
    v_accvgpr_write_b32 a10, v1
    v_accvgpr_write_b32 a11, v1
    v_accvgpr_write_b32 a12, v1
    v_accvgpr_write_b32 a13, v1
    v_accvgpr_write_b32 a14, v1
    v_accvgpr_write_b32 a15, v1
    v_accvgpr_write_b32 a16, v1
    v_accvgpr_write_b32 a17, v1
    v_accvgpr_write_b32 a18, v1
    v_accvgpr_write_b32 a19, v1
    v_accvgpr_write_b32 a20, v1
    v_accvgpr_write_b32 a21, v1
    v_accvgpr_write_b32 a22, v1
    v_accvgpr_write_b32 a23, v1
    v_accvgpr_write_b32 a24, v1
    v_accvgpr_write_b32 a25, v1
    v_accvgpr_write_b32 a36, v1
    v_accvgpr_write_b32 a37, v1
    v_accvgpr_write_b32 a38, v1
    v_accvgpr_write_b32 a39, v1
    v_accvgpr_write_b32 a40, v1
    v_accvgpr_write_b32 a41, v1
    v_accvgpr_write_b32 a42, v1
    v_accvgpr_write_b32 a43, v1
    v_accvgpr_write_b32 a44, v1
    v_accvgpr_write_b32 a45, v1
    v_accvgpr_write_b32 a46, v1
    v_accvgpr_write_b32 a47, v1
    v_accvgpr_write_b32 a48, v1
    v_accvgpr_write_b32 a49, v1
    v_accvgpr_write_b32 a50, v1
    v_accvgpr_write_b32 a51, v1
    v_mov_b32 v174, 0x40000000
    v_mov_b32_e64 v154, v174
    s_mov_b32 s17, 0x0
    s_and_b32 s48, s2, 3
    s_lshl_b32 s48, s48, 2
    s_bfe_u32 s49, s2, 0x20003
    s_add_u32 s48, s48, s49
    s_bfe_u32 s49, s2, 0x10002
    s_lshl_b32 s49, s49, 3
    s_lshr_b32 s50, s2, 5
    s_add_u32 s49, s49, s50
    s_mul_i32 s48, s48, 163840
    s_add_u32 s17, s17, s48
    s_lshl_b32 s49, s3, 12
    s_add_u32 s8, s4, s17
    s_addc_u32 s9, s5, 0
    s_mov_b32 s10, 0x28000
    s_mov_b32 s11, 0x20000
    s_and_b32 s48, s2, 3
    s_lshl_b32 s48, s48, 2
    s_bfe_u32 s49, s2, 0x20003
    s_add_u32 s48, s48, s49
    s_bfe_u32 s49, s2, 0x10002
    s_lshl_b32 s49, s49, 3
    s_lshr_b32 s50, s2, 5
    s_add_u32 s49, s49, s50
    s_lshl_b32 s7, s7, 3
    s_add_u32 s7, s7, s6
    s_add_u32 s18, s18, 256
    s_min_u32 s19, s2, 200
    s_add_u32 s19, s19, 512
    v_mov_b32_e64 v2, s7
    v_writelane_b32 v2, s18, 1
    v_writelane_b32 v2, s19, 2
    v_lshlrev_b32 v2, 7, v2
    s_add_u32 s100, s100, 1
    s_add_u32 s101, s101, 1
    v_mov_b32 v254, s100
    v_mov_b32 v255, s101
    s_lshl_b32 s49, s49, 4
    v_and_b32 v3, 15, v252
    v_add_u32_e64 v3, s49, v3
    s_mul_i32 s6, s6, 5
    s_lshr_b32 s6, s6, 2
    s_mul_i32 s6, s6, 10
    s_add_u32 s6, s6, 468
    v_add_u32 v6, s6, v252
    v_cmp_le_u32 vcc, 44, v252
    s_nop 1
    v_cndmask_b32 v3, v3, v6, vcc
    s_mul_i32 s6, s48, 5
    s_lshr_b32 s6, s6, 1
    s_add_u32 s7, s6, 256
    v_writelane_b32 v3, s7, 16
    s_add_u32 s7, s6, 257
    v_writelane_b32 v3, s7, 17
    s_add_u32 s7, s6, 258
    v_writelane_b32 v3, s7, 18
    s_add_u32 s7, s6, 296
    v_writelane_b32 v3, s7, 19
    s_add_u32 s7, s6, 297
    v_writelane_b32 v3, s7, 20
    s_add_u32 s7, s6, 298
    v_writelane_b32 v3, s7, 21
    s_add_u32 s7, s6, 336
    v_writelane_b32 v3, s7, 22
    s_add_u32 s7, s6, 337
    v_writelane_b32 v3, s7, 23
    s_add_u32 s7, s6, 338
    v_writelane_b32 v3, s7, 24
    s_lshr_b32 s7, s48, 1
    s_add_u32 s7, s7, 496
    v_writelane_b32 v3, s7, 25
    v_lshlrev_b32 v3, 7, v3
L_m_qtop:
    s_and_b32 s6, s2, 3
    s_lshl_b32 s6, s6, 2
    s_bfe_u32 s7, s2, 0x20003
    s_add_u32 s6, s6, s7
    s_bfe_u32 s7, s2, 0x10002
    s_lshl_b32 s7, s7, 3
    s_lshr_b32 s16, s2, 5
    s_add_u32 s7, s7, s16
    s_lshl_b32 s16, s7, 2
    s_add_u32 s16, s16, s3
    s_mul_i32 s18, s16, 43008
    s_mul_i32 s19, s97, 2752512
    s_add_u32 s18, s18, s19
    s_add_u32 s18, s18, 0x7f8000
    s_add_u32 s12, s4, s18
    s_addc_u32 s13, s5, 0
    s_mov_b32 s14, 0xa800
    s_mov_b32 s15, 0x20000
    s_mov_b32 s24, s4
    s_mov_b32 s25, s5
    s_mov_b32 s26, 0x2b78000
    s_mov_b32 s27, 0x20000
    s_bfe_u32 s52, s2, 0x30003
    s_and_b32 s53, s2, 7
    s_lshl_b32 s53, s53, 2
    s_lshr_b32 s54, s2, 6
    s_add_u32 s53, s53, s54
    s_lshl_b32 s19, s3, 12
    s_lshl_b32 s55, s3, 10
    v_add_u32_e64 v146, s19, v253
    s_lshl_b32 s53, s3, 9
    v_and_b32 v160, 0x1ff, v253
    v_add_u32 v160, s53, v160
    s_lshr_b32 s53, s97, 1
    s_mul_i32 s62, s97, 2621440
    s_add_u32 s62, s62, 0x1278000
    s_mul_i32 s61, s53, 7864320
    s_add_u32 s61, s61, 0x1c78000
    s_mul_i32 s63, s53, 524288
    s_add_u32 s63, s63, 0x690000
    s_mul_i32 s52, s52, 102400
    s_bitcmp1_b32 s97, 0
    s_cselect_b32 s62, s61, s62
    s_cselect_b32 s63, 0, s63
    s_cselect_b32 s53, 819200, 0
    s_add_u32 s52, s52, s53
    s_add_u32 s52, s52, 0x500000
    s_mul_i32 s53, s3, 25600
    s_add_u32 s53, s53, 24576
    s_add_u32 s48, s4, s52
    s_addc_u32 s49, s5, 0
    s_mov_b32 s50, 0x19000
    s_mov_b32 s51, 0x20000
    v_lshrrev_b32 v161, 5, v252
    v_and_b32 v162, 31, v252
    v_lshlrev_b32_e64 v163, 10, v161
    v_lshl_add_u32 v163, v162, 2, v163
    s_cmp_eq_u32 s97, 0
    s_cbranch_scc1 L_m_qproA
    s_lshl_b32 s22, s96, 4
    s_add_u32 s22, s22, s7
    s_lshl_b32 s22, s22, 2
    s_add_u32 s22, s22, s3
    s_lshl_b32 s22, s22, 7
    s_add_u32 s22, s22, 0x78e000
    v_lshlrev_b32_e64 v154, 5, v252
    s_cmp_lg_u32 s3, 0
    s_waitcnt vmcnt(0)
    s_barrier
    s_cbranch_scc1 L_m_pub636
    s_mov_b64 exec, 1
    buffer_store_dwordx2 v[254:255], off, s[56:59], s60 sc1
    s_mov_b64 exec, -1
L_m_pub636:
    s_add_u32 s96, s96, 1
    s_cmp_lg_u32 s63, 0
    s_cbranch_scc1 L_m_qproA
    s_mul_i32 s28, s3, 1280
    v_mul_u32_u24 v148, 5120, v161
    v_add_u32_e64 v148, s28, v148
    v_lshl_add_u32 v164, v162, 4, v148
    v_lshl_add_u32 v165, v162, 3, v148
    v_mul_u32_u24 v148, 0x28000, v161
    v_lshl_add_u32 v166, v162, 4, v148
    v_lshl_add_u32 v167, v162, 3, v148
    s_mul_i32 s29, s6, 327680
    s_lshr_b32 s30, s16, 1
    s_mul_i32 s30, s30, 5120
    s_add_u32 s29, s29, s30
    s_add_u32 s29, s29, s62
    s_add_u32 s29, s29, 0x280000
    s_and_b32 s33, s16, 1
    s_lshl_b32 s30, s33, 10
    s_add_u32 s30, s30, s29
    s_lshl_b32 s31, s33, 8
    s_add_u32 s31, s31, s29
    s_mul_i32 s32, s33, 1280
    s_add_u32 s32, s32, s29
    v_mul_u32_u24 v168, 40, v252
    v_add_u32 v168, s19, v168
    v_lshrrev_b32 v148, 4, v252
    v_and_b32_e64 v149, 3, v252
    v_lshl_add_u32 v148, v148, 2, v149
    v_bfe_u32 v149, v252, 2, 2
    v_add_u32 v150, 0, v148
    v_mul_u32_u24 v151, 0x34, v150
    v_lshrrev_b32 v151, 8, v151
    v_mul_u32_u24 v152, 5, v151
    v_sub_u32 v152, v150, v152
    v_lshrrev_b32 v153, 1, v151
    v_lshl_add_u32 v153, v153, 4, v149
    v_and_b32_e64 v151, 1, v151
    v_lshl_add_u32 v153, v151, 2, v153
    v_mul_u32_u24_e64 v153, 40, v153
    v_lshl_add_u32 v153, v152, 3, v153
    v_add_u32 v169, s19, v153
    v_add_u32 v150, 16, v148
    v_mul_u32_u24 v151, 0x34, v150
    v_lshrrev_b32 v151, 8, v151
    v_mul_u32_u24 v152, 5, v151
    v_sub_u32 v152, v150, v152
    v_lshrrev_b32_e64 v153, 1, v151
    v_lshl_add_u32 v153, v153, 4, v149
    v_and_b32_e64 v151, 1, v151
    v_lshl_add_u32 v153, v151, 2, v153
    v_mul_u32_u24_e64 v153, 40, v153
    v_lshl_add_u32 v153, v152, 3, v153
    v_add_u32 v170, s19, v153
    v_add_u32 v150, 32, v148
    v_mul_u32_u24 v151, 0x34, v150
    v_lshrrev_b32 v151, 8, v151
    v_mul_u32_u24 v152, 5, v151
    v_sub_u32 v152, v150, v152
    v_lshrrev_b32_e64 v153, 1, v151
    v_lshl_add_u32 v153, v153, 4, v149
    v_and_b32_e64 v151, 1, v151
    v_lshl_add_u32 v153, v151, 2, v153
    v_mul_u32_u24_e64 v153, 40, v153
    v_lshl_add_u32 v153, v152, 3, v153
    v_add_u32 v171, s19, v153
    v_mov_b32_e64 v172, v253
    v_cmp_gt_u32 vcc, 16, v252
    v_add_u32 v148, 1024, v253
    v_add_u32 v149, 0x27f00, v253
    v_cndmask_b32 v173, v149, v148, vcc
    v_cmp_gt_u32 vcc, 32, v252
    v_add_u32 v148, 0x28300, v253
    v_mov_b32 v149, 0x40000000
    v_cndmask_b32 v174, v149, v148, vcc
    s_branch L_m_qmain
L_m_qproA:
    s_lshl_b32 s28, s3, 5
    v_lshl_add_u32 v148, v161, 7, v162
    v_add_u32_e64 v148, s28, v148
    v_mul_u32_u24 v164, 96, v148
    v_bfe_u32 v148, v252, 2, 2
    v_lshl_add_u32 v148, v161, 3, v148
    s_lshl_b32 s28, s3, 7
    v_add_u32 v148, s28, v148
    v_mul_u32_u24 v148, 96, v148
    v_bfe_u32 v149, v252, 4, 1
    v_and_b32_e64 v150, 1, v252
    v_bfe_u32 v151, v252, 1, 1
    v_lshl_add_u32 v150, v150, 1, v151
    v_lshl_add_u32 v150, v149, 2, v150
    v_min_u32_e64 v150, 4, v150
    v_lshl_add_u32 v165, v150, 3, v148
    v_and_b32_e64 v150, 3, v252
    v_lshl_add_u32 v150, v149, 2, v150
    v_min_u32_e64 v150, 5, v150
    v_lshl_add_u32 v166, v150, 3, v148
    v_min_u32_e64 v148, 20, v162
    v_mad_u32_u24 v149, v161, 21, v148
    v_lshlrev_b32 v171, 4, v149
    v_lshlrev_b32 v172, 3, v149
    v_mov_b32_e64 v150, 0x40000000
    s_mul_i32 s28, s3, 672
    s_mul_i32 s29, s3, 168
    v_add_u32 v148, s28, v171
    v_cmp_gt_u32 vcc, 21, v162
    v_add_u32 v149, s29, v172
    s_nop 0
    v_cndmask_b32 v167, v150, v148, vcc
    v_cmp_gt_u32 vcc, 21, v252
    v_lshl_add_u32 v170, v161, 3, v160
    v_lshl_add_u32 v148, v161, 14, v160
    v_cndmask_b32 v168, v150, v149, vcc
    v_cmp_gt_u32 vcc, 1680, v160
    s_lshl_b32 s30, s6, 15
    s_add_u32 s30, s30, s63
    v_cndmask_b32 v169, v150, v148, vcc
    s_lshl_b32 s31, s7, 11
    s_add_u32 s31, s31, s30
    s_and_b32 s32, s6, 1
    s_lshl_b32 s32, s32, 9
    v_cmp_gt_u32 vcc, 32, v252
    v_add_u32 v148, s32, v253
    s_mul_i32 s32, s16, 40960
    s_add_u32 s32, s32, s62
    v_cndmask_b32 v173, v150, v148, vcc
    s_lshr_b32 s33, s6, 1
    s_add_u32 s33, s33, 32
    s_lshl_b32 s33, s33, 10
    s_add_u32 s33, s33, s32
    s_lshl_b32 s34, s6, 11
    s_add_u32 s32, s32, s34
    s_add_u32 s40, s30, 0
    s_add_u32 s41, s30, 4096
    s_add_u32 s42, s30, 8192
    s_add_u32 s43, s30, 12288
L_m_qmain:
    s_cmp_eq_u32 s97, 0
    s_cbranch_scc1 L_m_psync
    s_mov_b32 s23, 0x40000
    s_mov_b64 exec, 15
    .p2align 5
L_m_poll789:
    buffer_load_dwordx2 v[148:149], v154, s[56:59], s22 offen sc1
    s_sub_u32 s23, s23, 1
    s_cbranch_scc1 L_m_poll789x
    s_waitcnt vmcnt(0)
    v_cmp_ne_u64 vcc, s[100:101], v[148:149]
    s_and_b64 exec, vcc, vcc
    s_cbranch_scc1 L_m_poll789
L_m_poll789x:
    s_mov_b64 exec, -1
    s_barrier
L_m_qgo:
    s_mov_b32 s21, 0
    buffer_load_dwordx4 v[80:83], v253, s[12:15], s21 offen offset:0 sc1
    buffer_load_dwordx4 v[84:87], v253, s[12:15], s21 offen offset:1024 sc1
    buffer_load_dwordx4 v[88:91], v253, s[12:15], s21 offen offset:2048 sc1
    buffer_load_dwordx4 v[92:95], v253, s[12:15], s21 offen offset:3072 sc1
    s_mov_b32 s21, 4096
    buffer_load_dwordx4 v[96:99], v253, s[12:15], s21 offen offset:0 sc1
    buffer_load_dwordx4 v[100:103], v253, s[12:15], s21 offen offset:1024 sc1
    buffer_load_dwordx4 v[104:107], v253, s[12:15], s21 offen offset:2048 sc1
    buffer_load_dwordx4 v[108:111], v253, s[12:15], s21 offen offset:3072 sc1
    s_mov_b32 s21, 8192
    buffer_load_dwordx4 v[112:115], v253, s[12:15], s21 offen offset:0 sc1
    buffer_load_dwordx4 v[116:119], v253, s[12:15], s21 offen offset:1024 sc1
    buffer_load_dwordx4 v[120:123], v253, s[12:15], s21 offen offset:2048 sc1
    buffer_load_dwordx4 v[124:127], v253, s[12:15], s21 offen offset:3072 sc1
    s_mov_b32 s22, 40960
    s_waitcnt vmcnt(8)
    s_barrier
    ds_read_b128 v[64:67], v253 offset:0
    ds_read_b128 v[68:71], v253 offset:1024
    ds_read_b128 v[72:75], v253 offset:2048
    ds_read_b128 v[76:79], v253 offset:3072
    s_add_u32 m0, s19, 49152
    s_mov_b32 s20, 49152
    s_mov_b32 s21, 12288
    buffer_load_dwordx4 a[52:55], v253, s[12:15], s21 offen offset:0 sc1
    buffer_load_dwordx4 v146, s[8:11], s20 offen offset:1024 sc1 lds
    s_waitcnt lgkmcnt(3)
    v_mfma_f32_32x32x16_bf16 v[0:15], v[64:67], v[80:83], 0
    ds_read_b128 v[64:67], v253 offset:4096
    s_waitcnt lgkmcnt(3)
    v_mfma_f32_32x32x16_bf16 v[16:31], v[68:71], v[80:83], 0
    ds_read_b128 v[68:71], v253 offset:5120
    buffer_load_dwordx4 a[56:59], v253, s[12:15], s21 offen offset:1024 sc1
    s_waitcnt lgkmcnt(3)
    v_mfma_f32_32x32x16_bf16 v[32:47], v[72:75], v[80:83], 0
    ds_read_b128 v[72:75], v253 offset:6144
    buffer_load_dwordx4 v146, s[8:11], s20 offen offset:2048 sc1 lds
    s_waitcnt lgkmcnt(3)
    v_mfma_f32_32x32x16_bf16 v[48:63], v[76:79], v[80:83], 0
    ds_read_b128 v[76:79], v253 offset:7168
    s_waitcnt lgkmcnt(3)
    v_mfma_f32_32x32x16_bf16 v[0:15], v[64:67], v[84:87], v[0:15]
    ds_read_b128 v[64:67], v253 offset:8192
    s_waitcnt lgkmcnt(3)
    v_mfma_f32_32x32x16_bf16 v[16:31], v[68:71], v[84:87], v[16:31]
    ds_read_b128 v[68:71], v253 offset:9216
    buffer_load_dwordx4 a[60:63], v253, s[12:15], s21 offen offset:2048 sc1
    s_waitcnt lgkmcnt(3)
    v_mfma_f32_32x32x16_bf16 v[32:47], v[72:75], v[84:87], v[32:47]
    ds_read_b128 v[72:75], v253 offset:10240
    buffer_load_dwordx4 v146, s[8:11], s20 offen offset:3072 sc1 lds
    s_waitcnt lgkmcnt(3)
    v_mfma_f32_32x32x16_bf16 v[48:63], v[76:79], v[84:87], v[48:63]
    ds_read_b128 v[76:79], v253 offset:11264
    s_waitcnt lgkmcnt(3)
    v_mfma_f32_32x32x16_bf16 v[0:15], v[64:67], v[88:91], v[0:15]
    ds_read_b128 v[64:67], v253 offset:12288
    s_waitcnt lgkmcnt(3)
    v_mfma_f32_32x32x16_bf16 v[16:31], v[68:71], v[88:91], v[16:31]
    ds_read_b128 v[68:71], v253 offset:13312
    buffer_load_dwordx4 a[64:67], v253, s[12:15], s21 offen offset:3072 sc1
    s_waitcnt lgkmcnt(3)
    v_mfma_f32_32x32x16_bf16 v[32:47], v[72:75], v[88:91], v[32:47]
    ds_read_b128 v[72:75], v253 offset:14336
    s_waitcnt lgkmcnt(3)
    v_mfma_f32_32x32x16_bf16 v[48:63], v[76:79], v[88:91], v[48:63]
    ds_read_b128 v[76:79], v253 offset:15360
    s_waitcnt vmcnt(11) lgkmcnt(3)
    s_barrier
    v_mfma_f32_32x32x16_bf16 v[0:15], v[64:67], v[92:95], v[0:15]
    ds_read_b128 v[64:67], v253 offset:16384
    s_add_u32 m0, s19, 0
    s_mov_b32 s20, 65536
    s_mov_b32 s21, 16384
    s_waitcnt lgkmcnt(3)
    v_mfma_f32_32x32x16_bf16 v[16:31], v[68:71], v[92:95], v[16:31]
    ds_read_b128 v[68:71], v253 offset:17408
    buffer_load_dwordx4 a[68:71], v253, s[12:15], s21 offen offset:0 sc1
    s_waitcnt lgkmcnt(3)
    v_mfma_f32_32x32x16_bf16 v[32:47], v[72:75], v[92:95], v[32:47]
    ds_read_b128 v[72:75], v253 offset:18432
    buffer_load_dwordx4 v146, s[8:11], s20 offen offset:1024 sc1 lds
    s_waitcnt lgkmcnt(3)
    v_mfma_f32_32x32x16_bf16 v[48:63], v[76:79], v[92:95], v[48:63]
    ds_read_b128 v[76:79], v253 offset:19456
    s_waitcnt lgkmcnt(3)
    v_mfma_f32_32x32x16_bf16 v[0:15], v[64:67], v[96:99], v[0:15]
    ds_read_b128 v[64:67], v253 offset:20480
    s_waitcnt lgkmcnt(3)
    v_mfma_f32_32x32x16_bf16 v[16:31], v[68:71], v[96:99], v[16:31]
    ds_read_b128 v[68:71], v253 offset:21504
    buffer_load_dwordx4 a[72:75], v253, s[12:15], s21 offen offset:1024 sc1
    s_waitcnt lgkmcnt(3)
    v_mfma_f32_32x32x16_bf16 v[32:47], v[72:75], v[96:99], v[32:47]
    ds_read_b128 v[72:75], v253 offset:22528
    buffer_load_dwordx4 v146, s[8:11], s20 offen offset:2048 sc1 lds
    s_waitcnt lgkmcnt(3)
    v_mfma_f32_32x32x16_bf16 v[48:63], v[76:79], v[96:99], v[48:63]
    ds_read_b128 v[76:79], v253 offset:23552
    s_waitcnt lgkmcnt(3)
    v_mfma_f32_32x32x16_bf16 v[0:15], v[64:67], v[100:103], v[0:15]
    ds_read_b128 v[64:67], v253 offset:24576
    s_waitcnt lgkmcnt(3)
    v_mfma_f32_32x32x16_bf16 v[16:31], v[68:71], v[100:103], v[16:31]
    ds_read_b128 v[68:71], v253 offset:25600
    buffer_load_dwordx4 a[76:79], v253, s[12:15], s21 offen offset:2048 sc1
    s_waitcnt lgkmcnt(3)
    v_mfma_f32_32x32x16_bf16 v[32:47], v[72:75], v[100:103], v[32:47]
    ds_read_b128 v[72:75], v253 offset:26624
    buffer_load_dwordx4 v146, s[8:11], s20 offen offset:3072 sc1 lds
    s_waitcnt lgkmcnt(3)
    v_mfma_f32_32x32x16_bf16 v[48:63], v[76:79], v[100:103], v[48:63]
    ds_read_b128 v[76:79], v253 offset:27648
    s_waitcnt lgkmcnt(3)
    v_mfma_f32_32x32x16_bf16 v[0:15], v[64:67], v[104:107], v[0:15]
    ds_read_b128 v[64:67], v253 offset:28672
    s_waitcnt lgkmcnt(3)
    v_mfma_f32_32x32x16_bf16 v[16:31], v[68:71], v[104:107], v[16:31]
    ds_read_b128 v[68:71], v253 offset:29696
    buffer_load_dwordx4 a[80:83], v253, s[12:15], s21 offen offset:3072 sc1
    s_waitcnt lgkmcnt(3)
    v_mfma_f32_32x32x16_bf16 v[32:47], v[72:75], v[104:107], v[32:47]
    ds_read_b128 v[72:75], v253 offset:30720
    s_waitcnt lgkmcnt(3)
    v_mfma_f32_32x32x16_bf16 v[48:63], v[76:79], v[104:107], v[48:63]
    ds_read_b128 v[76:79], v253 offset:31744
    s_waitcnt vmcnt(14) lgkmcnt(3)
    s_barrier
    v_mfma_f32_32x32x16_bf16 v[0:15], v[64:67], v[108:111], v[0:15]
    ds_read_b128 v[64:67], v253 offset:32768
    s_add_u32 m0, s19, 16384
    s_mov_b32 s20, 81920
    s_mov_b32 s21, 20480
    s_waitcnt lgkmcnt(3)
    v_mfma_f32_32x32x16_bf16 v[16:31], v[68:71], v[108:111], v[16:31]
    ds_read_b128 v[68:71], v253 offset:33792
    buffer_load_dwordx4 a[84:87], v253, s[12:15], s21 offen offset:0 sc1
    s_waitcnt lgkmcnt(3)
    v_mfma_f32_32x32x16_bf16 v[32:47], v[72:75], v[108:111], v[32:47]
    ds_read_b128 v[72:75], v253 offset:34816
    buffer_load_dwordx4 v146, s[8:11], s20 offen offset:1024 sc1 lds
    s_waitcnt lgkmcnt(3)
    v_mfma_f32_32x32x16_bf16 v[48:63], v[76:79], v[108:111], v[48:63]
    ds_read_b128 v[76:79], v253 offset:35840
    s_waitcnt lgkmcnt(3)
    v_mfma_f32_32x32x16_bf16 v[0:15], v[64:67], v[112:115], v[0:15]
    ds_read_b128 v[64:67], v253 offset:36864
    s_waitcnt lgkmcnt(3)
    v_mfma_f32_32x32x16_bf16 v[16:31], v[68:71], v[112:115], v[16:31]
    ds_read_b128 v[68:71], v253 offset:37888
    buffer_load_dwordx4 a[88:91], v253, s[12:15], s21 offen offset:1024 sc1
    s_waitcnt lgkmcnt(3)
    v_mfma_f32_32x32x16_bf16 v[32:47], v[72:75], v[112:115], v[32:47]
    ds_read_b128 v[72:75], v253 offset:38912
    buffer_load_dwordx4 v146, s[8:11], s20 offen offset:2048 sc1 lds
    s_waitcnt lgkmcnt(3)
    v_mfma_f32_32x32x16_bf16 v[48:63], v[76:79], v[112:115], v[48:63]
    ds_read_b128 v[76:79], v253 offset:39936
    s_waitcnt lgkmcnt(3)
    v_mfma_f32_32x32x16_bf16 v[0:15], v[64:67], v[116:119], v[0:15]
    ds_read_b128 v[64:67], v253 offset:40960
    s_waitcnt lgkmcnt(3)
    v_mfma_f32_32x32x16_bf16 v[16:31], v[68:71], v[116:119], v[16:31]
    ds_read_b128 v[68:71], v253 offset:41984
    buffer_load_dwordx4 a[92:95], v253, s[12:15], s21 offen offset:2048 sc1
    s_waitcnt lgkmcnt(3)
    v_mfma_f32_32x32x16_bf16 v[32:47], v[72:75], v[116:119], v[32:47]
    ds_read_b128 v[72:75], v253 offset:43008
    buffer_load_dwordx4 v146, s[8:11], s20 offen offset:3072 sc1 lds
    s_waitcnt lgkmcnt(3)
    v_mfma_f32_32x32x16_bf16 v[48:63], v[76:79], v[116:119], v[48:63]
    ds_read_b128 v[76:79], v253 offset:44032
    s_waitcnt lgkmcnt(3)
    v_mfma_f32_32x32x16_bf16 v[0:15], v[64:67], v[120:123], v[0:15]
    ds_read_b128 v[64:67], v253 offset:45056
    s_waitcnt lgkmcnt(3)
    v_mfma_f32_32x32x16_bf16 v[16:31], v[68:71], v[120:123], v[16:31]
    ds_read_b128 v[68:71], v253 offset:46080
    buffer_load_dwordx4 a[96:99], v253, s[12:15], s21 offen offset:3072 sc1
    s_waitcnt lgkmcnt(3)
    v_mfma_f32_32x32x16_bf16 v[32:47], v[72:75], v[120:123], v[32:47]
    ds_read_b128 v[72:75], v253 offset:47104
    s_waitcnt lgkmcnt(3)
    v_mfma_f32_32x32x16_bf16 v[48:63], v[76:79], v[120:123], v[48:63]
    ds_read_b128 v[76:79], v253 offset:48128
    s_waitcnt vmcnt(14) lgkmcnt(3)
    s_barrier
    v_mfma_f32_32x32x16_bf16 v[0:15], v[64:67], v[124:127], v[0:15]
    s_add_u32 m0, s19, 32768
    s_mov_b32 s20, 98304
    s_mov_b32 s21, 24576
    s_waitcnt lgkmcnt(2)
    v_mfma_f32_32x32x16_bf16 v[16:31], v[68:71], v[124:127], v[16:31]
    ds_read_b128 v[68:71], v253 offset:50176
    buffer_load_dwordx4 a[100:103], v253, s[12:15], s21 offen offset:0 sc1
    s_waitcnt lgkmcnt(2)
    v_mfma_f32_32x32x16_bf16 v[32:47], v[72:75], v[124:127], v[32:47]
    ds_read_b128 v[72:75], v253 offset:51200
    buffer_load_dwordx4 v146, s[8:11], s20 offen offset:1024 sc1 lds
    s_waitcnt lgkmcnt(2)
    v_mfma_f32_32x32x16_bf16 v[48:63], v[76:79], v[124:127], v[48:63]
    ds_read_b128 v[76:79], v253 offset:52224
    s_waitcnt lgkmcnt(2)
    v_mfma_f32_32x32x16_bf16 v[16:31], v[68:71], a[52:55], v[16:31]
    ds_read_b128 v[68:71], v253 offset:54272
    s_waitcnt lgkmcnt(2)
    v_mfma_f32_32x32x16_bf16 v[32:47], v[72:75], a[52:55], v[32:47]
    ds_read_b128 v[72:75], v253 offset:55296
    buffer_load_dwordx4 a[104:107], v253, s[12:15], s21 offen offset:1024 sc1
    s_waitcnt lgkmcnt(2)
    v_mfma_f32_32x32x16_bf16 v[48:63], v[76:79], a[52:55], v[48:63]
    ds_read_b128 v[76:79], v253 offset:56320
    buffer_load_dwordx4 v146, s[8:11], s20 offen offset:2048 sc1 lds
    s_waitcnt lgkmcnt(2)
    v_mfma_f32_32x32x16_bf16 v[16:31], v[68:71], a[56:59], v[16:31]
    ds_read_b128 v[68:71], v253 offset:58368
    s_waitcnt lgkmcnt(2)
    v_mfma_f32_32x32x16_bf16 v[32:47], v[72:75], a[56:59], v[32:47]
    ds_read_b128 v[72:75], v253 offset:59392
    buffer_load_dwordx4 a[108:111], v253, s[12:15], s21 offen offset:2048 sc1
    s_waitcnt lgkmcnt(2)
    v_mfma_f32_32x32x16_bf16 v[48:63], v[76:79], a[56:59], v[48:63]
    ds_read_b128 v[76:79], v253 offset:60416
    buffer_load_dwordx4 v146, s[8:11], s20 offen offset:3072 sc1 lds
    s_waitcnt lgkmcnt(2)
    v_mfma_f32_32x32x16_bf16 v[16:31], v[68:71], a[60:63], v[16:31]
    ds_read_b128 v[68:71], v253 offset:62464
    s_waitcnt lgkmcnt(2)
    v_mfma_f32_32x32x16_bf16 v[32:47], v[72:75], a[60:63], v[32:47]
    ds_read_b128 v[72:75], v253 offset:63488
    buffer_load_dwordx4 a[112:115], v253, s[12:15], s21 offen offset:3072 sc1
    s_waitcnt lgkmcnt(2)
    v_mfma_f32_32x32x16_bf16 v[48:63], v[76:79], a[60:63], v[48:63]
    ds_read_b128 v[76:79], v253 offset:64512
    s_waitcnt vmcnt(14) lgkmcnt(2)
    s_barrier
    v_mfma_f32_32x32x16_bf16 v[16:31], v[68:71], a[64:67], v[16:31]
    ds_read_b128 v[68:71], v253 offset:1024
    s_add_u32 m0, s19, 49152
    s_mov_b32 s20, 114688
    s_mov_b32 s21, 28672
    s_waitcnt lgkmcnt(2)
    v_mfma_f32_32x32x16_bf16 v[32:47], v[72:75], a[64:67], v[32:47]
    ds_read_b128 v[72:75], v253 offset:2048
    buffer_load_dwordx4 a[116:119], v253, s[12:15], s21 offen offset:0 sc1
    s_waitcnt lgkmcnt(2)
    v_mfma_f32_32x32x16_bf16 v[48:63], v[76:79], a[64:67], v[48:63]
    ds_read_b128 v[76:79], v253 offset:3072
    buffer_load_dwordx4 v146, s[8:11], s20 offen offset:1024 sc1 lds
    s_waitcnt lgkmcnt(2)
    v_mfma_f32_32x32x16_bf16 v[16:31], v[68:71], a[68:71], v[16:31]
    ds_read_b128 v[68:71], v253 offset:5120
    s_waitcnt lgkmcnt(2)
    v_mfma_f32_32x32x16_bf16 v[32:47], v[72:75], a[68:71], v[32:47]
    ds_read_b128 v[72:75], v253 offset:6144
    buffer_load_dwordx4 a[120:123], v253, s[12:15], s21 offen offset:1024 sc1
    s_waitcnt lgkmcnt(2)
    v_mfma_f32_32x32x16_bf16 v[48:63], v[76:79], a[68:71], v[48:63]
    ds_read_b128 v[76:79], v253 offset:7168
    buffer_load_dwordx4 v146, s[8:11], s20 offen offset:2048 sc1 lds
    s_waitcnt lgkmcnt(2)
    v_mfma_f32_32x32x16_bf16 v[16:31], v[68:71], a[72:75], v[16:31]
    ds_read_b128 v[68:71], v253 offset:9216
    s_waitcnt lgkmcnt(2)
    v_mfma_f32_32x32x16_bf16 v[32:47], v[72:75], a[72:75], v[32:47]
    ds_read_b128 v[72:75], v253 offset:10240
    buffer_load_dwordx4 a[124:127], v253, s[12:15], s21 offen offset:2048 sc1
    s_waitcnt lgkmcnt(2)
    v_mfma_f32_32x32x16_bf16 v[48:63], v[76:79], a[72:75], v[48:63]
    ds_read_b128 v[76:79], v253 offset:11264
    buffer_load_dwordx4 v146, s[8:11], s20 offen offset:3072 sc1 lds
    s_waitcnt lgkmcnt(2)
    v_mfma_f32_32x32x16_bf16 v[16:31], v[68:71], a[76:79], v[16:31]
    ds_read_b128 v[68:71], v253 offset:13312
    s_waitcnt lgkmcnt(2)
    v_mfma_f32_32x32x16_bf16 v[32:47], v[72:75], a[76:79], v[32:47]
    ds_read_b128 v[72:75], v253 offset:14336
    buffer_load_dwordx4 a[128:131], v253, s[12:15], s21 offen offset:3072 sc1
    s_waitcnt lgkmcnt(2)
    v_mfma_f32_32x32x16_bf16 v[48:63], v[76:79], a[76:79], v[48:63]
    ds_read_b128 v[76:79], v253 offset:15360
    s_waitcnt vmcnt(14) lgkmcnt(2)
    s_barrier
    v_mfma_f32_32x32x16_bf16 v[16:31], v[68:71], a[80:83], v[16:31]
    ds_read_b128 v[68:71], v253 offset:17408
    s_add_u32 m0, s19, 0
    s_mov_b32 s20, 131072
    s_mov_b32 s21, 32768
    s_waitcnt lgkmcnt(2)
    v_mfma_f32_32x32x16_bf16 v[32:47], v[72:75], a[80:83], v[32:47]
    ds_read_b128 v[72:75], v253 offset:18432
    buffer_load_dwordx4 a[132:135], v253, s[12:15], s21 offen offset:0 sc1
    s_waitcnt lgkmcnt(2)
    v_mfma_f32_32x32x16_bf16 v[48:63], v[76:79], a[80:83], v[48:63]
    ds_read_b128 v[76:79], v253 offset:19456
    buffer_load_dwordx4 v146, s[8:11], s20 offen offset:1024 sc1 lds
    s_waitcnt lgkmcnt(2)
    v_mfma_f32_32x32x16_bf16 v[16:31], v[68:71], a[84:87], v[16:31]
    ds_read_b128 v[68:71], v253 offset:21504
    s_waitcnt lgkmcnt(2)
    v_mfma_f32_32x32x16_bf16 v[32:47], v[72:75], a[84:87], v[32:47]
    ds_read_b128 v[72:75], v253 offset:22528
    buffer_load_dwordx4 a[136:139], v253, s[12:15], s21 offen offset:1024 sc1
    s_waitcnt lgkmcnt(2)
    v_mfma_f32_32x32x16_bf16 v[48:63], v[76:79], a[84:87], v[48:63]
    ds_read_b128 v[76:79], v253 offset:23552
    buffer_load_dwordx4 v146, s[8:11], s20 offen offset:2048 sc1 lds
    s_waitcnt lgkmcnt(2)
    v_mfma_f32_32x32x16_bf16 v[16:31], v[68:71], a[88:91], v[16:31]
    ds_read_b128 v[68:71], v253 offset:25600
    s_waitcnt lgkmcnt(2)
    v_mfma_f32_32x32x16_bf16 v[32:47], v[72:75], a[88:91], v[32:47]
    ds_read_b128 v[72:75], v253 offset:26624
    buffer_load_dwordx4 a[140:143], v253, s[12:15], s21 offen offset:2048 sc1
    s_waitcnt lgkmcnt(2)
    v_mfma_f32_32x32x16_bf16 v[48:63], v[76:79], a[88:91], v[48:63]
    ds_read_b128 v[76:79], v253 offset:27648
    buffer_load_dwordx4 v146, s[8:11], s20 offen offset:3072 sc1 lds
    s_waitcnt lgkmcnt(2)
    v_mfma_f32_32x32x16_bf16 v[16:31], v[68:71], a[92:95], v[16:31]
    ds_read_b128 v[68:71], v253 offset:29696
    s_waitcnt lgkmcnt(2)
    v_mfma_f32_32x32x16_bf16 v[32:47], v[72:75], a[92:95], v[32:47]
    ds_read_b128 v[72:75], v253 offset:30720
    buffer_load_dwordx4 a[144:147], v253, s[12:15], s21 offen offset:3072 sc1
    s_waitcnt lgkmcnt(2)
    v_mfma_f32_32x32x16_bf16 v[48:63], v[76:79], a[92:95], v[48:63]
    ds_read_b128 v[76:79], v253 offset:31744
    s_waitcnt vmcnt(14) lgkmcnt(2)
    s_barrier
    v_mfma_f32_32x32x16_bf16 v[16:31], v[68:71], a[96:99], v[16:31]
    ds_read_b128 v[68:71], v253 offset:33792
    s_add_u32 m0, s19, 16384
    s_mov_b32 s20, 147456
    s_mov_b32 s21, 36864
    s_waitcnt lgkmcnt(2)
    v_mfma_f32_32x32x16_bf16 v[32:47], v[72:75], a[96:99], v[32:47]
    ds_read_b128 v[72:75], v253 offset:34816
    buffer_load_dwordx4 a[148:151], v253, s[12:15], s21 offen offset:0 sc1
    s_waitcnt lgkmcnt(2)
    v_mfma_f32_32x32x16_bf16 v[48:63], v[76:79], a[96:99], v[48:63]
    ds_read_b128 v[76:79], v253 offset:35840
    buffer_load_dwordx4 v146, s[8:11], s20 offen offset:1024 sc1 lds
    s_waitcnt lgkmcnt(2)
    v_mfma_f32_32x32x16_bf16 v[16:31], v[68:71], a[100:103], v[16:31]
    ds_read_b128 v[68:71], v253 offset:37888
    s_waitcnt lgkmcnt(2)
    v_mfma_f32_32x32x16_bf16 v[32:47], v[72:75], a[100:103], v[32:47]
    ds_read_b128 v[72:75], v253 offset:38912
    buffer_load_dwordx4 a[152:155], v253, s[12:15], s21 offen offset:1024 sc1
    s_waitcnt lgkmcnt(2)
    v_mfma_f32_32x32x16_bf16 v[48:63], v[76:79], a[100:103], v[48:63]
    ds_read_b128 v[76:79], v253 offset:39936
    buffer_load_dwordx4 v146, s[8:11], s20 offen offset:2048 sc1 lds
    s_waitcnt lgkmcnt(2)
    v_mfma_f32_32x32x16_bf16 v[16:31], v[68:71], a[104:107], v[16:31]
    ds_read_b128 v[68:71], v253 offset:41984
    s_waitcnt lgkmcnt(2)
    v_mfma_f32_32x32x16_bf16 v[32:47], v[72:75], a[104:107], v[32:47]
    ds_read_b128 v[72:75], v253 offset:43008
    buffer_load_dwordx4 a[156:159], v253, s[12:15], s21 offen offset:2048 sc1
    s_waitcnt lgkmcnt(2)
    v_mfma_f32_32x32x16_bf16 v[48:63], v[76:79], a[104:107], v[48:63]
    ds_read_b128 v[76:79], v253 offset:44032
    buffer_load_dwordx4 v146, s[8:11], s20 offen offset:3072 sc1 lds
    s_waitcnt lgkmcnt(2)
    v_mfma_f32_32x32x16_bf16 v[16:31], v[68:71], a[108:111], v[16:31]
    ds_read_b128 v[68:71], v253 offset:46080
    s_waitcnt lgkmcnt(2)
    v_mfma_f32_32x32x16_bf16 v[32:47], v[72:75], a[108:111], v[32:47]
    ds_read_b128 v[72:75], v253 offset:47104
    buffer_load_dwordx4 a[160:163], v253, s[12:15], s21 offen offset:3072 sc1
    s_waitcnt lgkmcnt(2)
    v_mfma_f32_32x32x16_bf16 v[48:63], v[76:79], a[108:111], v[48:63]
    ds_read_b128 v[76:79], v253 offset:48128
    s_waitcnt vmcnt(14) lgkmcnt(2)
    s_barrier
    v_mfma_f32_32x32x16_bf16 v[16:31], v[68:71], a[112:115], v[16:31]
    ds_read_b128 v[68:71], v253 offset:50176
    buffer_load_dword v180, v163, s[12:15], s22 offen offset:0 sc1
    s_waitcnt lgkmcnt(2)
    v_mfma_f32_32x32x16_bf16 v[32:47], v[72:75], a[112:115], v[32:47]
    ds_read_b128 v[72:75], v253 offset:51200
    s_waitcnt lgkmcnt(2)
    v_mfma_f32_32x32x16_bf16 v[48:63], v[76:79], a[112:115], v[48:63]
    ds_read_b128 v[76:79], v253 offset:52224
    buffer_load_dword v181, v163, s[12:15], s22 offen offset:128 sc1
    s_waitcnt lgkmcnt(2)
    v_mfma_f32_32x32x16_bf16 v[16:31], v[68:71], a[116:119], v[16:31]
    ds_read_b128 v[68:71], v253 offset:54272
    buffer_load_dword v182, v163, s[12:15], s22 offen offset:256 sc1
    s_add_u32 m0, s55, 32768
    s_mov_b32 s20, 98304
    s_waitcnt lgkmcnt(2)
    v_mfma_f32_32x32x16_bf16 v[32:47], v[72:75], a[116:119], v[32:47]
    ds_read_b128 v[72:75], v253 offset:55296
    buffer_load_dwordx4 v146, s[8:11], s20 offen offset:0 sc1 lds
    s_waitcnt lgkmcnt(2)
    v_mfma_f32_32x32x16_bf16 v[48:63], v[76:79], a[116:119], v[48:63]
    ds_read_b128 v[76:79], v253 offset:56320
    buffer_load_dword v183, v163, s[12:15], s22 offen offset:384 sc1
    s_waitcnt lgkmcnt(2)
    v_mfma_f32_32x32x16_bf16 v[16:31], v[68:71], a[120:123], v[16:31]
    ds_read_b128 v[68:71], v253 offset:58368
    buffer_load_dword v184, v163, s[12:15], s22 offen offset:512 sc1
    s_add_u32 m0, s55, 36864
    s_mov_b32 s20, 114688
    s_waitcnt lgkmcnt(2)
    v_mfma_f32_32x32x16_bf16 v[32:47], v[72:75], a[120:123], v[32:47]
    ds_read_b128 v[72:75], v253 offset:59392
    buffer_load_dwordx4 v146, s[8:11], s20 offen offset:0 sc1 lds
    s_waitcnt lgkmcnt(2)
    v_mfma_f32_32x32x16_bf16 v[48:63], v[76:79], a[120:123], v[48:63]
    ds_read_b128 v[76:79], v253 offset:60416
    buffer_load_dword v185, v163, s[12:15], s22 offen offset:640 sc1
    s_waitcnt lgkmcnt(2)
    v_mfma_f32_32x32x16_bf16 v[16:31], v[68:71], a[124:127], v[16:31]
    ds_read_b128 v[68:71], v253 offset:62464
    buffer_load_dword v186, v163, s[12:15], s22 offen offset:768 sc1
    s_add_u32 m0, s55, 40960
    s_mov_b32 s20, 131072
    s_waitcnt lgkmcnt(2)
    v_mfma_f32_32x32x16_bf16 v[32:47], v[72:75], a[124:127], v[32:47]
    ds_read_b128 v[72:75], v253 offset:63488
    buffer_load_dwordx4 v146, s[8:11], s20 offen offset:0 sc1 lds
    s_waitcnt lgkmcnt(2)
    v_mfma_f32_32x32x16_bf16 v[48:63], v[76:79], a[124:127], v[48:63]
    ds_read_b128 v[76:79], v253 offset:64512
    buffer_load_dword v187, v163, s[12:15], s22 offen offset:896 sc1
    s_waitcnt vmcnt(18) lgkmcnt(2)
    s_barrier
    v_mfma_f32_32x32x16_bf16 v[16:31], v[68:71], a[128:131], v[16:31]
    ds_read_b128 v[68:71], v253 offset:1024
    s_add_u32 m0, s55, 45056
    s_mov_b32 s20, 147456
    s_waitcnt lgkmcnt(2)
    v_mfma_f32_32x32x16_bf16 v[32:47], v[72:75], a[128:131], v[32:47]
    ds_read_b128 v[72:75], v253 offset:2048
    buffer_load_dwordx4 v146, s[8:11], s20 offen offset:0 sc1 lds
    s_waitcnt lgkmcnt(2)
    v_mfma_f32_32x32x16_bf16 v[48:63], v[76:79], a[128:131], v[48:63]
    ds_read_b128 v[76:79], v253 offset:3072
    s_waitcnt lgkmcnt(2)
    v_mfma_f32_32x32x16_bf16 v[16:31], v[68:71], a[132:135], v[16:31]
    ds_read_b128 v[68:71], v253 offset:5120
    s_add_u32 m0, s55, 49152
    s_mov_b32 s20, 49152
    s_waitcnt lgkmcnt(2)
    v_mfma_f32_32x32x16_bf16 v[32:47], v[72:75], a[132:135], v[32:47]
    ds_read_b128 v[72:75], v253 offset:6144
    buffer_load_dwordx4 v146, s[8:11], s20 offen offset:0 sc1 lds
    s_waitcnt lgkmcnt(2)
    v_mfma_f32_32x32x16_bf16 v[48:63], v[76:79], a[132:135], v[48:63]
    ds_read_b128 v[76:79], v253 offset:7168
    s_waitcnt lgkmcnt(2)
    v_mfma_f32_32x32x16_bf16 v[16:31], v[68:71], a[136:139], v[16:31]
    ds_read_b128 v[68:71], v253 offset:9216
    s_add_u32 m0, s55, 53248
    s_mov_b32 s20, 65536
    s_waitcnt lgkmcnt(2)
    v_mfma_f32_32x32x16_bf16 v[32:47], v[72:75], a[136:139], v[32:47]
    ds_read_b128 v[72:75], v253 offset:10240
    buffer_load_dwordx4 v146, s[8:11], s20 offen offset:0 sc1 lds
    s_waitcnt lgkmcnt(2)
    v_mfma_f32_32x32x16_bf16 v[48:63], v[76:79], a[136:139], v[48:63]
    ds_read_b128 v[76:79], v253 offset:11264
    s_waitcnt lgkmcnt(2)
    v_mfma_f32_32x32x16_bf16 v[16:31], v[68:71], a[140:143], v[16:31]
    ds_read_b128 v[68:71], v253 offset:13312
    s_add_u32 m0, s55, 57344
    s_mov_b32 s20, 81920
    s_waitcnt lgkmcnt(2)
    v_mfma_f32_32x32x16_bf16 v[32:47], v[72:75], a[140:143], v[32:47]
    ds_read_b128 v[72:75], v253 offset:14336
    buffer_load_dwordx4 v146, s[8:11], s20 offen offset:0 sc1 lds
    s_waitcnt lgkmcnt(2)
    v_mfma_f32_32x32x16_bf16 v[48:63], v[76:79], a[140:143], v[48:63]
    ds_read_b128 v[76:79], v253 offset:15360
    s_waitcnt vmcnt(15) lgkmcnt(2)
    s_barrier
    v_mfma_f32_32x32x16_bf16 v[16:31], v[68:71], a[144:147], v[16:31]
    ds_read_b128 v[68:71], v253 offset:17408
    s_waitcnt lgkmcnt(2)
    v_mfma_f32_32x32x16_bf16 v[32:47], v[72:75], a[144:147], v[32:47]
    ds_read_b128 v[72:75], v253 offset:18432
    s_waitcnt lgkmcnt(2)
    v_mfma_f32_32x32x16_bf16 v[48:63], v[76:79], a[144:147], v[48:63]
    ds_read_b128 v[76:79], v253 offset:19456
    s_waitcnt lgkmcnt(2)
    v_mfma_f32_32x32x16_bf16 v[16:31], v[68:71], a[148:151], v[16:31]
    ds_read_b128 v[68:71], v253 offset:21504
    s_waitcnt lgkmcnt(2)
    v_mfma_f32_32x32x16_bf16 v[32:47], v[72:75], a[148:151], v[32:47]
    ds_read_b128 v[72:75], v253 offset:22528
    s_waitcnt lgkmcnt(2)
    v_mfma_f32_32x32x16_bf16 v[48:63], v[76:79], a[148:151], v[48:63]
    ds_read_b128 v[76:79], v253 offset:23552
    s_waitcnt lgkmcnt(2)
    v_mfma_f32_32x32x16_bf16 v[16:31], v[68:71], a[152:155], v[16:31]
    ds_read_b128 v[68:71], v253 offset:25600
    s_waitcnt vmcnt(4)
    v_add_f32_e64 v180, v180, v184
    s_waitcnt lgkmcnt(2)
    v_mfma_f32_32x32x16_bf16 v[32:47], v[72:75], a[152:155], v[32:47]
    ds_read_b128 v[72:75], v253 offset:26624
    v_add_f32 v181, v181, v185
    s_waitcnt lgkmcnt(2)
    v_mfma_f32_32x32x16_bf16 v[48:63], v[76:79], a[152:155], v[48:63]
    ds_read_b128 v[76:79], v253 offset:27648
    v_add_f32 v182, v182, v186
    s_waitcnt lgkmcnt(2)
    v_mfma_f32_32x32x16_bf16 v[16:31], v[68:71], a[156:159], v[16:31]
    ds_read_b128 v[68:71], v253 offset:29696
    v_add_f32 v183, v183, v187
    s_waitcnt lgkmcnt(2)
    v_mfma_f32_32x32x16_bf16 v[32:47], v[72:75], a[156:159], v[32:47]
    ds_read_b128 v[72:75], v253 offset:30720
    v_add_f32 v180, v180, v182
    s_waitcnt lgkmcnt(2)
    v_mfma_f32_32x32x16_bf16 v[48:63], v[76:79], a[156:159], v[48:63]
    ds_read_b128 v[76:79], v253 offset:31744
    v_add_f32 v181, v181, v183
    s_waitcnt lgkmcnt(2)
    v_mfma_f32_32x32x16_bf16 v[16:31], v[68:71], a[160:163], v[16:31]
    v_add_f32 v147, v180, v181
    v_add_f32_e64 v148, v180, v181
    s_waitcnt lgkmcnt(1)
    v_mfma_f32_32x32x16_bf16 v[32:47], v[72:75], a[160:163], v[32:47]
    s_waitcnt lgkmcnt(0)
    v_mfma_f32_32x32x16_bf16 v[48:63], v[76:79], a[160:163], v[48:63]
    v_permlane32_swap_b32 v148, v147
    v_add_f32_e64 v147, v148, v147
    v_mov_b32 v149, 0x3727c5ac
    v_fmac_f32 v149, 0x3acccccd, v147
    s_nop 7
    v_mul_f32 v148, 0x3acccccd, v60
    v_fma_f32 v149, -v148, v148, v149
    v_rsq_f32 v156, v149
    s_cmp_lg_u32 s63, 0
    s_cbranch_scc1 L_m_qepiA
    v_pk_mul_f32 v[40:41], v[40:41], v[156:157] op_sel_hi:[1,0]
    v_pk_mul_f32 v[42:43], v[42:43], v[156:157] op_sel_hi:[1,0]
    v_cvt_pk_bf16_f32 v92, v40, v41
    v_pk_mul_f32 v[44:45], v[44:45], v[156:157] op_sel_hi:[1,0]
    v_cvt_pk_bf16_f32 v93, v42, v43
    v_pk_mul_f32 v[46:47], v[46:47], v[156:157] op_sel_hi:[1,0]
    v_cvt_pk_bf16_f32 v94, v44, v45
    v_pk_mul_f32 v[48:49], v[48:49], v[156:157] op_sel_hi:[1,0]
    v_cvt_pk_bf16_f32 v95, v46, v47
    v_pk_mul_f32 v[50:51], v[50:51], v[156:157] op_sel_hi:[1,0]
    v_cvt_pk_bf16_f32 v96, v48, v49
    v_pk_mul_f32 v[52:53], v[52:53], v[156:157] op_sel_hi:[1,0]
    v_cvt_pk_bf16_f32 v97, v50, v51
    v_pk_mul_f32 v[54:55], v[54:55], v[156:157] op_sel_hi:[1,0]
    v_cvt_pk_bf16_f32 v98, v52, v53
    v_pk_mul_f32 v[56:57], v[56:57], v[156:157] op_sel_hi:[1,0]
    v_cvt_pk_bf16_f32 v99, v54, v55
    v_pk_mul_f32 v[58:59], v[58:59], v[156:157] op_sel_hi:[1,0]
    v_cvt_pk_bf16_f32 v100, v56, v57
    v_cvt_pk_bf16_f32 v101, v58, v59
    ds_write_b64 v168, v[92:93] offset:0
    ds_write_b64 v168, v[94:95] offset:8
    ds_write_b64 v168, v[96:97] offset:16
    ds_write_b64 v168, v[98:99] offset:24
    ds_write_b64 v168, v[100:101] offset:32
    v_pk_mul_f32 v[20:21], v[20:21], v[156:157] op_sel_hi:[1,0]
    v_pk_mul_f32 v[22:23], v[22:23], v[156:157] op_sel_hi:[1,0]
    v_cvt_pk_bf16_f32 v82, v20, v21
    v_pk_mul_f32 v[24:25], v[24:25], v[156:157] op_sel_hi:[1,0]
    v_cvt_pk_bf16_f32 v83, v22, v23
    v_pk_mul_f32 v[26:27], v[26:27], v[156:157] op_sel_hi:[1,0]
    v_cvt_pk_bf16_f32 v84, v24, v25
    v_pk_mul_f32 v[28:29], v[28:29], v[156:157] op_sel_hi:[1,0]
    v_cvt_pk_bf16_f32 v85, v26, v27
    v_pk_mul_f32 v[30:31], v[30:31], v[156:157] op_sel_hi:[1,0]
    v_cvt_pk_bf16_f32 v86, v28, v29
    v_pk_mul_f32 v[32:33], v[32:33], v[156:157] op_sel_hi:[1,0]
    v_cvt_pk_bf16_f32 v87, v30, v31
    v_pk_mul_f32 v[34:35], v[34:35], v[156:157] op_sel_hi:[1,0]
    v_cvt_pk_bf16_f32 v88, v32, v33
    v_pk_mul_f32 v[36:37], v[36:37], v[156:157] op_sel_hi:[1,0]
    v_cvt_pk_bf16_f32 v89, v34, v35
    v_pk_mul_f32 v[38:39], v[38:39], v[156:157] op_sel_hi:[1,0]
    v_cvt_pk_bf16_f32 v90, v36, v37
    v_cvt_pk_bf16_f32 v91, v38, v39
    buffer_store_dwordx4 v[82:85], v166, s[24:27], s30 offen sc1
    buffer_store_dwordx4 v[86:89], v166, s[24:27], s30 offen offset:512 sc1
    buffer_store_dwordx2 v[90:91], v167, s[24:27], s31 offen offset:2048 sc1
    s_waitcnt lgkmcnt(0)
    ds_read_b64_tr_b16 v[104:105], v169
    ds_read_b64_tr_b16 v[106:107], v169 offset:320
    ds_read_b64_tr_b16 v[108:109], v170
    ds_read_b64_tr_b16 v[110:111], v170 offset:320
    ds_read_b64_tr_b16 v[112:113], v171
    ds_read_b64_tr_b16 v[114:115], v171 offset:320
    s_waitcnt lgkmcnt(4)
    buffer_store_dwordx4 v[104:107], v172, s[24:27], s32 offen offset:2560 sc1
    s_waitcnt lgkmcnt(2)
    buffer_store_dwordx4 v[108:111], v173, s[24:27], s32 offen offset:2560 sc1
    s_waitcnt lgkmcnt(0)
    buffer_store_dwordx4 v[112:115], v174, s[24:27], s32 offen offset:2560 sc1
    s_waitcnt vmcnt(6)
    s_barrier
    ds_read_b128 v[64:67], v253 offset:49152
    ds_read_b128 v[68:71], v253 offset:50176
    ds_read_b128 v[72:75], v253 offset:51200
    ds_read_b128 v[76:79], v253 offset:52224
    s_waitcnt lgkmcnt(3)
    v_mfma_f32_32x32x16_bf16 v[0:15], v[64:67], a[52:55], v[0:15]
    ds_read_b128 v[64:67], v253 offset:53248
    s_waitcnt lgkmcnt(3)
    v_mfma_f32_32x32x16_bf16 v[0:15], v[68:71], a[56:59], v[0:15]
    ds_read_b128 v[68:71], v253 offset:54272
    s_waitcnt lgkmcnt(3)
    v_mfma_f32_32x32x16_bf16 v[0:15], v[72:75], a[60:63], v[0:15]
    ds_read_b128 v[72:75], v253 offset:55296
    s_waitcnt lgkmcnt(3)
    v_mfma_f32_32x32x16_bf16 v[0:15], v[76:79], a[64:67], v[0:15]
    ds_read_b128 v[76:79], v253 offset:56320
    s_waitcnt lgkmcnt(3)
    v_mfma_f32_32x32x16_bf16 v[0:15], v[64:67], a[68:71], v[0:15]
    ds_read_b128 v[64:67], v253 offset:57344
    s_waitcnt lgkmcnt(3)
    v_mfma_f32_32x32x16_bf16 v[0:15], v[68:71], a[72:75], v[0:15]
    ds_read_b128 v[68:71], v253 offset:58368
    s_waitcnt lgkmcnt(3)
    v_mfma_f32_32x32x16_bf16 v[0:15], v[72:75], a[76:79], v[0:15]
    ds_read_b128 v[72:75], v253 offset:59392
    s_waitcnt lgkmcnt(3)
    v_mfma_f32_32x32x16_bf16 v[0:15], v[76:79], a[80:83], v[0:15]
    ds_read_b128 v[76:79], v253 offset:60416
    s_waitcnt lgkmcnt(3)
    v_mfma_f32_32x32x16_bf16 v[0:15], v[64:67], a[84:87], v[0:15]
    ds_read_b128 v[64:67], v253 offset:32768
    s_waitcnt lgkmcnt(3)
    v_mfma_f32_32x32x16_bf16 v[0:15], v[68:71], a[88:91], v[0:15]
    ds_read_b128 v[68:71], v253 offset:33792
    s_waitcnt lgkmcnt(3)
    v_mfma_f32_32x32x16_bf16 v[0:15], v[72:75], a[92:95], v[0:15]
    ds_read_b128 v[72:75], v253 offset:34816
    s_waitcnt lgkmcnt(3)
    v_mfma_f32_32x32x16_bf16 v[0:15], v[76:79], a[96:99], v[0:15]
    ds_read_b128 v[76:79], v253 offset:35840
    s_waitcnt lgkmcnt(3)
    v_mfma_f32_32x32x16_bf16 v[0:15], v[64:67], a[100:103], v[0:15]
    ds_read_b128 v[64:67], v253 offset:36864
    s_waitcnt lgkmcnt(3)
    v_mfma_f32_32x32x16_bf16 v[0:15], v[68:71], a[104:107], v[0:15]
    ds_read_b128 v[68:71], v253 offset:37888
    s_waitcnt lgkmcnt(3)
    v_mfma_f32_32x32x16_bf16 v[0:15], v[72:75], a[108:111], v[0:15]
    ds_read_b128 v[72:75], v253 offset:38912
    s_waitcnt lgkmcnt(3)
    v_mfma_f32_32x32x16_bf16 v[0:15], v[76:79], a[112:115], v[0:15]
    ds_read_b128 v[76:79], v253 offset:39936
    s_waitcnt lgkmcnt(3)
    v_mfma_f32_32x32x16_bf16 v[0:15], v[64:67], a[116:119], v[0:15]
    ds_read_b128 v[64:67], v253 offset:40960
    s_waitcnt lgkmcnt(3)
    v_mfma_f32_32x32x16_bf16 v[0:15], v[68:71], a[120:123], v[0:15]
    ds_read_b128 v[68:71], v253 offset:41984
    s_waitcnt lgkmcnt(3)
    v_mfma_f32_32x32x16_bf16 v[0:15], v[72:75], a[124:127], v[0:15]
    ds_read_b128 v[72:75], v253 offset:43008
    s_waitcnt lgkmcnt(3)
    v_mfma_f32_32x32x16_bf16 v[0:15], v[76:79], a[128:131], v[0:15]
    ds_read_b128 v[76:79], v253 offset:44032
    s_lshl_b32 s60, s96, 4
    s_add_u32 s60, s60, s6
    s_lshl_b32 s60, s60, 4
    s_add_u32 s60, s60, s7
    s_lshl_b32 s60, s60, 5
    s_add_u32 s60, s60, 0x78e000
    s_branch L_m_atop
L_m_qepiA:
    v_mul_f32 v158, 0x3fb8aa3b, v156
    v_mov_b32 v160, 0x358637bd
    v_pk_mul_f32 v[40:41], v[40:41], v[156:157] op_sel_hi:[1,0]
    v_pk_mul_f32 v[42:43], v[42:43], v[156:157] op_sel_hi:[1,0]
    v_cvt_pk_bf16_f32 v86, v40, v41
    v_pk_mul_f32 v[44:45], v[44:45], v[156:157] op_sel_hi:[1,0]
    v_cvt_pk_bf16_f32 v87, v42, v43
    v_pk_mul_f32 v[46:47], v[46:47], v[156:157] op_sel_hi:[1,0]
    v_cvt_pk_bf16_f32 v88, v44, v45
    v_pk_mul_f32 v[48:49], v[48:49], v[156:157] op_sel_hi:[1,0]
    v_cvt_pk_bf16_f32 v89, v46, v47
    v_pk_mul_f32 v[50:51], v[50:51], v[156:157] op_sel_hi:[1,0]
    v_cvt_pk_bf16_f32 v90, v48, v49
    v_pk_mul_f32 v[52:53], v[52:53], v[156:157] op_sel_hi:[1,0]
    v_cvt_pk_bf16_f32 v91, v50, v51
    v_pk_mul_f32 v[54:55], v[54:55], v[156:157] op_sel_hi:[1,0]
    v_cvt_pk_bf16_f32 v92, v52, v53
    v_pk_mul_f32 v[56:57], v[56:57], v[156:157] op_sel_hi:[1,0]
    v_cvt_pk_bf16_f32 v93, v54, v55
    v_pk_mul_f32 v[58:59], v[58:59], v[156:157] op_sel_hi:[1,0]
    v_cvt_pk_bf16_f32 v94, v56, v57
    v_cvt_pk_bf16_f32 v95, v58, v59
    s_waitcnt vmcnt(0)
    s_barrier
    v_mov_b32 v96, 0x3f803f80
    v_mov_b32 v97, 0x3f803f80
    ds_write_b128 v164, v[88:91] offset:48
    ds_write_b128 v164, v[92:95] offset:64
    ds_write_b64 v164, v[96:97] offset:80
    s_add_u32 m0, s53, 61440
    s_nop 0
    buffer_load_dwordx4 v253, s[48:51], s53 offen offset:0 sc1 lds
    v_pk_mul_f32 v[120:121], v[20:21], v[158:159] op_sel_hi:[1,0]
    v_max_f32 v20, 0, v20
    v_exp_f32 v120, v120 clamp
    v_exp_f32 v121, v121 clamp
    v_max_f32_e64 v21, 0, v21
    v_pk_fma_f32 v[20:21], v[20:21], v[156:157], v[160:161] op_sel_hi:[1,0,0]
    v_pk_add_f32 v[20:21], v[20:21], v[120:121]
    v_pk_mul_f32 v[122:123], v[22:23], v[158:159] op_sel_hi:[1,0]
    v_max_f32_e64 v22, 0, v22
    v_exp_f32 v122, v122 clamp
    v_exp_f32 v123, v123 clamp
    v_max_f32_e64 v23, 0, v23
    v_cvt_pk_bf16_f32 v76, v20, v21
    v_pk_fma_f32 v[22:23], v[22:23], v[156:157], v[160:161] op_sel_hi:[1,0,0]
    v_pk_add_f32 v[22:23], v[22:23], v[122:123]
    s_sub_u32 s53, s53, 4096
    s_add_u32 m0, s53, 61440
    s_nop 0
    buffer_load_dwordx4 v253, s[48:51], s53 offen offset:3072 sc1 lds
    v_pk_mul_f32 v[120:121], v[24:25], v[158:159] op_sel_hi:[1,0]
    v_max_f32 v24, 0, v24
    v_exp_f32 v120, v120 clamp
    v_exp_f32 v121, v121 clamp
    v_max_f32_e64 v25, 0, v25
    v_cvt_pk_bf16_f32 v77, v22, v23
    v_pk_fma_f32 v[24:25], v[24:25], v[156:157], v[160:161] op_sel_hi:[1,0,0]
    v_pk_add_f32 v[24:25], v[24:25], v[120:121]
    v_pk_mul_f32 v[122:123], v[26:27], v[158:159] op_sel_hi:[1,0]
    v_max_f32_e64 v26, 0, v26
    v_exp_f32 v122, v122 clamp
    v_exp_f32 v123, v123 clamp
    v_max_f32_e64 v27, 0, v27
    v_cvt_pk_bf16_f32 v78, v24, v25
    v_pk_fma_f32 v[26:27], v[26:27], v[156:157], v[160:161] op_sel_hi:[1,0,0]
    v_pk_add_f32 v[26:27], v[26:27], v[122:123]
    buffer_load_dwordx4 v253, s[48:51], s53 offen offset:2048 sc1 lds
    v_pk_mul_f32 v[120:121], v[28:29], v[158:159] op_sel_hi:[1,0]
    v_max_f32_e64 v28, 0, v28
    v_exp_f32 v120, v120 clamp
    v_exp_f32 v121, v121 clamp
    v_max_f32_e64 v29, 0, v29
    v_cvt_pk_bf16_f32 v79, v26, v27
    v_pk_fma_f32 v[28:29], v[28:29], v[156:157], v[160:161] op_sel_hi:[1,0,0]
    v_pk_add_f32 v[28:29], v[28:29], v[120:121]
    v_pk_mul_f32 v[122:123], v[30:31], v[158:159] op_sel_hi:[1,0]
    v_max_f32_e64 v30, 0, v30
    v_exp_f32 v122, v122 clamp
    v_exp_f32 v123, v123 clamp
    v_max_f32_e64 v31, 0, v31
    v_cvt_pk_bf16_f32 v80, v28, v29
    v_pk_fma_f32 v[30:31], v[30:31], v[156:157], v[160:161] op_sel_hi:[1,0,0]
    v_pk_add_f32 v[30:31], v[30:31], v[122:123]
    buffer_load_dwordx4 v253, s[48:51], s53 offen offset:1024 sc1 lds
    v_pk_mul_f32 v[120:121], v[32:33], v[158:159] op_sel_hi:[1,0]
    v_max_f32_e64 v32, 0, v32
    v_exp_f32 v120, v120 clamp
    v_exp_f32 v121, v121 clamp
    v_max_f32_e64 v33, 0, v33
    v_cvt_pk_bf16_f32 v81, v30, v31
    v_pk_fma_f32 v[32:33], v[32:33], v[156:157], v[160:161] op_sel_hi:[1,0,0]
    v_pk_add_f32 v[32:33], v[32:33], v[120:121]
    v_pk_mul_f32 v[122:123], v[34:35], v[158:159] op_sel_hi:[1,0]
    v_max_f32_e64 v34, 0, v34
    v_exp_f32 v122, v122 clamp
    v_exp_f32 v123, v123 clamp
    v_max_f32_e64 v35, 0, v35
    v_cvt_pk_bf16_f32 v82, v32, v33
    v_pk_fma_f32 v[34:35], v[34:35], v[156:157], v[160:161] op_sel_hi:[1,0,0]
    v_pk_add_f32 v[34:35], v[34:35], v[122:123]
    buffer_load_dwordx4 v253, s[48:51], s53 offen offset:0 sc1 lds
    v_pk_mul_f32 v[120:121], v[36:37], v[158:159] op_sel_hi:[1,0]
    v_max_f32_e64 v36, 0, v36
    v_exp_f32 v120, v120 clamp
    v_exp_f32 v121, v121 clamp
    v_max_f32_e64 v37, 0, v37
    v_cvt_pk_bf16_f32 v83, v34, v35
    v_pk_fma_f32 v[36:37], v[36:37], v[156:157], v[160:161] op_sel_hi:[1,0,0]
    v_pk_add_f32 v[36:37], v[36:37], v[120:121]
    v_pk_mul_f32 v[122:123], v[38:39], v[158:159] op_sel_hi:[1,0]
    v_max_f32_e64 v38, 0, v38
    v_exp_f32 v122, v122 clamp
    v_exp_f32 v123, v123 clamp
    v_max_f32_e64 v39, 0, v39
    v_cvt_pk_bf16_f32 v84, v36, v37
    v_pk_fma_f32 v[38:39], v[38:39], v[156:157], v[160:161] op_sel_hi:[1,0,0]
    v_pk_add_f32 v[38:39], v[38:39], v[122:123]
    s_sub_u32 s53, s53, 4096
    s_add_u32 m0, s53, 61440
    s_nop 0
    buffer_load_dwordx4 v253, s[48:51], s53 offen offset:3072 sc1 lds
    v_cvt_pk_bf16_f32 v85, v38, v39
    ds_write_b128 v164, v[76:79] offset:0
    ds_write_b128 v164, v[80:83] offset:16
    ds_write_b128 v164, v[84:87] offset:32
    s_waitcnt lgkmcnt(0)
    s_barrier
    s_cmp_ge_u32 s3, 2
    s_cbranch_scc1 L_m_qnokv
    ds_read_b64_tr_b16 v[76:77], v165 offset:0
    ds_read_b64_tr_b16 v[80:81], v166 offset:40
    ds_read_b64_tr_b16 v[78:79], v165 offset:384
    ds_read_b64_tr_b16 v[82:83], v166 offset:424
    ds_read_b64_tr_b16 v[84:85], v165 offset:1536
    ds_read_b64_tr_b16 v[88:89], v166 offset:1576
    ds_read_b64_tr_b16 v[86:87], v165 offset:1920
    ds_read_b64_tr_b16 v[90:91], v166 offset:1960
    ds_read_b64_tr_b16 v[92:93], v165 offset:3072
    ds_read_b64_tr_b16 v[96:97], v166 offset:3112
    ds_read_b64_tr_b16 v[94:95], v165 offset:3456
    ds_read_b64_tr_b16 v[98:99], v166 offset:3496
    ds_read_b64_tr_b16 v[100:101], v165 offset:4608
    ds_read_b64_tr_b16 v[104:105], v166 offset:4648
    ds_read_b64_tr_b16 v[102:103], v165 offset:4992
    ds_read_b64_tr_b16 v[106:107], v166 offset:5032
    s_waitcnt lgkmcnt(12)
    v_mfma_f32_32x32x16_bf16 v[24:39], v[76:79], v[80:83], 0
    ds_read_b64_tr_b16 v[108:109], v165 offset:6144
    ds_read_b64_tr_b16 v[112:113], v166 offset:6184
    ds_read_b64_tr_b16 v[110:111], v165 offset:6528
    ds_read_b64_tr_b16 v[114:115], v166 offset:6568
    s_waitcnt lgkmcnt(12)
    v_mfma_f32_32x32x16_bf16 v[24:39], v[84:87], v[88:91], v[24:39]
    ds_read_b64_tr_b16 v[116:117], v165 offset:7680
    ds_read_b64_tr_b16 v[120:121], v166 offset:7720
    ds_read_b64_tr_b16 v[118:119], v165 offset:8064
    ds_read_b64_tr_b16 v[122:123], v166 offset:8104
    s_waitcnt lgkmcnt(12)
    v_mfma_f32_32x32x16_bf16 v[24:39], v[92:95], v[96:99], v[24:39]
    ds_read_b64_tr_b16 v[124:125], v165 offset:9216
    ds_read_b64_tr_b16 v[128:129], v166 offset:9256
    ds_read_b64_tr_b16 v[126:127], v165 offset:9600
    ds_read_b64_tr_b16 v[130:131], v166 offset:9640
    s_waitcnt lgkmcnt(12)
    v_mfma_f32_32x32x16_bf16 v[24:39], v[100:103], v[104:107], v[24:39]
    ds_read_b64_tr_b16 v[132:133], v165 offset:10752
    ds_read_b64_tr_b16 v[136:137], v166 offset:10792
    ds_read_b64_tr_b16 v[134:135], v165 offset:11136
    ds_read_b64_tr_b16 v[138:139], v166 offset:11176
    s_waitcnt lgkmcnt(12)
    v_mfma_f32_32x32x16_bf16 v[24:39], v[108:111], v[112:115], v[24:39]
    s_waitcnt lgkmcnt(8)
    v_mfma_f32_32x32x16_bf16 v[24:39], v[116:119], v[120:123], v[24:39]
    s_waitcnt lgkmcnt(4)
    v_mfma_f32_32x32x16_bf16 v[24:39], v[124:127], v[128:131], v[24:39]
    s_waitcnt lgkmcnt(0)
    v_mfma_f32_32x32x16_bf16 v[24:39], v[132:135], v[136:139], v[24:39]
    s_nop 11
    v_cvt_pk_bf16_f32 v44, v24, v25
    v_cvt_pk_bf16_f32 v45, v26, v27
    v_cvt_pk_bf16_f32 v46, v28, v29
    v_cvt_pk_bf16_f32 v47, v30, v31
    v_cvt_pk_bf16_f32 v48, v32, v33
    v_cvt_pk_bf16_f32 v49, v34, v35
    v_min_u32 v44, -2, v44
    v_min_u32 v45, -2, v45
    v_min_u32 v46, -2, v46
    v_min_u32 v47, -2, v47
    v_min_u32 v48, -2, v48
    v_min_u32 v49, -2, v49
    buffer_store_dwordx4 v[44:47], v167, s[24:27], s31 offen sc1
    buffer_store_dwordx2 v[48:49], v168, s[24:27], s31 offen offset:1344 sc1
L_m_qnokv:
    ds_read_b128 v[64:67], v253 offset:49152
    ds_read_b128 v[68:71], v253 offset:50176
    ds_read_b128 v[72:75], v253 offset:51200
    ds_read_b128 v[76:79], v253 offset:52224
    s_waitcnt lgkmcnt(3)
    v_mfma_f32_32x32x16_bf16 v[0:15], v[64:67], a[52:55], v[0:15]
    ds_read_b128 v[64:67], v253 offset:53248
    buffer_load_dwordx4 v253, s[48:51], s53 offen offset:2048 sc1 lds
    s_waitcnt lgkmcnt(3)
    v_mfma_f32_32x32x16_bf16 v[0:15], v[68:71], a[56:59], v[0:15]
    ds_read_b128 v[68:71], v253 offset:54272
    buffer_load_dwordx4 v253, s[48:51], s53 offen offset:1024 sc1 lds
    s_waitcnt lgkmcnt(3)
    v_mfma_f32_32x32x16_bf16 v[0:15], v[72:75], a[60:63], v[0:15]
    ds_read_b128 v[72:75], v253 offset:55296
    buffer_load_dwordx4 v253, s[48:51], s53 offen offset:0 sc1 lds
    s_waitcnt lgkmcnt(3)
    v_mfma_f32_32x32x16_bf16 v[0:15], v[76:79], a[64:67], v[0:15]
    ds_read_b128 v[76:79], v253 offset:56320
    s_sub_u32 s53, s53, 4096
    s_add_u32 m0, s53, 61440
    s_nop 0
    buffer_load_dwordx4 v253, s[48:51], s53 offen offset:3072 sc1 lds
    s_waitcnt lgkmcnt(3)
    v_mfma_f32_32x32x16_bf16 v[0:15], v[64:67], a[68:71], v[0:15]
    ds_read_b128 v[64:67], v253 offset:57344
    buffer_load_dwordx4 v253, s[48:51], s53 offen offset:2048 sc1 lds
    s_waitcnt lgkmcnt(3)
    v_mfma_f32_32x32x16_bf16 v[0:15], v[68:71], a[72:75], v[0:15]
    ds_read_b128 v[68:71], v253 offset:58368
    buffer_load_dwordx4 v253, s[48:51], s53 offen offset:1024 sc1 lds
    s_waitcnt lgkmcnt(3)
    v_mfma_f32_32x32x16_bf16 v[0:15], v[72:75], a[76:79], v[0:15]
    ds_read_b128 v[72:75], v253 offset:59392
    buffer_load_dwordx4 v253, s[48:51], s53 offen offset:0 sc1 lds
    s_waitcnt lgkmcnt(3)
    v_mfma_f32_32x32x16_bf16 v[0:15], v[76:79], a[80:83], v[0:15]
    ds_read_b128 v[76:79], v253 offset:60416
    s_sub_u32 s53, s53, 4096
    s_add_u32 m0, s53, 61440
    s_nop 0
    buffer_load_dwordx4 v253, s[48:51], s53 offen offset:3072 sc1 lds
    s_waitcnt lgkmcnt(3)
    v_mfma_f32_32x32x16_bf16 v[0:15], v[64:67], a[84:87], v[0:15]
    ds_read_b128 v[64:67], v253 offset:32768
    buffer_load_dwordx4 v253, s[48:51], s53 offen offset:2048 sc1 lds
    s_waitcnt lgkmcnt(3)
    v_mfma_f32_32x32x16_bf16 v[0:15], v[68:71], a[88:91], v[0:15]
    ds_read_b128 v[68:71], v253 offset:33792
    buffer_load_dwordx4 v253, s[48:51], s53 offen offset:1024 sc1 lds
    s_waitcnt lgkmcnt(3)
    v_mfma_f32_32x32x16_bf16 v[0:15], v[72:75], a[92:95], v[0:15]
    ds_read_b128 v[72:75], v253 offset:34816
    buffer_load_dwordx4 v253, s[48:51], s53 offen offset:0 sc1 lds
    s_waitcnt lgkmcnt(3)
    v_mfma_f32_32x32x16_bf16 v[0:15], v[76:79], a[96:99], v[0:15]
    ds_read_b128 v[76:79], v253 offset:35840
    s_sub_u32 s53, s53, 4096
    s_add_u32 m0, s53, 61440
    s_nop 0
    buffer_load_dwordx4 v253, s[48:51], s53 offen offset:3072 sc1 lds
    s_waitcnt lgkmcnt(3)
    v_mfma_f32_32x32x16_bf16 v[0:15], v[64:67], a[100:103], v[0:15]
    ds_read_b128 v[64:67], v253 offset:36864
    buffer_load_dwordx4 v253, s[48:51], s53 offen offset:2048 sc1 lds
    s_waitcnt lgkmcnt(3)
    v_mfma_f32_32x32x16_bf16 v[0:15], v[68:71], a[104:107], v[0:15]
    ds_read_b128 v[68:71], v253 offset:37888
    buffer_load_dwordx4 v253, s[48:51], s53 offen offset:1024 sc1 lds
    s_waitcnt lgkmcnt(3)
    v_mfma_f32_32x32x16_bf16 v[0:15], v[72:75], a[108:111], v[0:15]
    ds_read_b128 v[72:75], v253 offset:38912
    buffer_load_dwordx4 v253, s[48:51], s53 offen offset:0 sc1 lds
    s_waitcnt lgkmcnt(3)
    v_mfma_f32_32x32x16_bf16 v[0:15], v[76:79], a[112:115], v[0:15]
    ds_read_b128 v[76:79], v253 offset:39936
    s_sub_u32 s53, s53, 4096
    s_add_u32 m0, s53, 61440
    s_nop 0
    buffer_load_dwordx4 v253, s[48:51], s53 offen offset:3072 sc1 lds
    s_waitcnt lgkmcnt(3)
    v_mfma_f32_32x32x16_bf16 v[0:15], v[64:67], a[116:119], v[0:15]
    ds_read_b128 v[64:67], v253 offset:40960
    buffer_load_dwordx4 v253, s[48:51], s53 offen offset:2048 sc1 lds
    s_waitcnt lgkmcnt(3)
    v_mfma_f32_32x32x16_bf16 v[0:15], v[68:71], a[120:123], v[0:15]
    ds_read_b128 v[68:71], v253 offset:41984
    buffer_load_dwordx4 v253, s[48:51], s53 offen offset:1024 sc1 lds
    s_waitcnt lgkmcnt(3)
    v_mfma_f32_32x32x16_bf16 v[0:15], v[72:75], a[124:127], v[0:15]
    ds_read_b128 v[72:75], v253 offset:43008
    buffer_load_dwordx4 v253, s[48:51], s53 offen offset:0 sc1 lds
    s_waitcnt lgkmcnt(3)
    v_mfma_f32_32x32x16_bf16 v[0:15], v[76:79], a[128:131], v[0:15]
    ds_read_b128 v[76:79], v253 offset:44032
    s_waitcnt lgkmcnt(3)
    v_mfma_f32_32x32x16_bf16 v[0:15], v[64:67], a[132:135], v[0:15]
    ds_read_b128 v[64:67], v253 offset:45056
    s_waitcnt lgkmcnt(3)
    v_mfma_f32_32x32x16_bf16 v[0:15], v[68:71], a[136:139], v[0:15]
    ds_read_b128 v[68:71], v253 offset:46080
    s_waitcnt lgkmcnt(3)
    v_mfma_f32_32x32x16_bf16 v[0:15], v[72:75], a[140:143], v[0:15]
    ds_read_b128 v[72:75], v253 offset:47104
    s_waitcnt lgkmcnt(3)
    v_mfma_f32_32x32x16_bf16 v[0:15], v[76:79], a[144:147], v[0:15]
    ds_read_b128 v[76:79], v253 offset:48128
    s_waitcnt lgkmcnt(3)
    v_mfma_f32_32x32x16_bf16 v[0:15], v[64:67], a[148:151], v[0:15]
    s_waitcnt lgkmcnt(2)
    v_mfma_f32_32x32x16_bf16 v[0:15], v[68:71], a[152:155], v[0:15]
    s_waitcnt lgkmcnt(1)
    v_mfma_f32_32x32x16_bf16 v[0:15], v[72:75], a[156:159], v[0:15]
    s_waitcnt lgkmcnt(0)
    v_mfma_f32_32x32x16_bf16 v[0:15], v[76:79], a[160:163], v[0:15]
    s_nop 11
    v_pk_mul_f32 v[120:121], v[0:1], v[158:159] op_sel_hi:[1,0]
    v_max_f32 v0, 0, v0
    v_exp_f32 v120, v120 clamp
    v_exp_f32 v121, v121 clamp
    v_max_f32_e64 v1, 0, v1
    v_pk_fma_f32 v[0:1], v[0:1], v[156:157], v[160:161] op_sel_hi:[1,0,0]
    v_pk_add_f32 v[0:1], v[0:1], v[120:121]
    v_pk_mul_f32 v[122:123], v[2:3], v[158:159] op_sel_hi:[1,0]
    v_max_f32_e64 v2, 0, v2
    v_exp_f32 v122, v122 clamp
    v_exp_f32 v123, v123 clamp
    v_max_f32_e64 v3, 0, v3
    v_cvt_pk_bf16_f32 v64, v0, v1
    v_pk_fma_f32 v[2:3], v[2:3], v[156:157], v[160:161] op_sel_hi:[1,0,0]
    v_pk_add_f32 v[2:3], v[2:3], v[122:123]
    v_pk_mul_f32 v[120:121], v[4:5], v[158:159] op_sel_hi:[1,0]
    v_max_f32_e64 v4, 0, v4
    v_exp_f32 v120, v120 clamp
    v_exp_f32 v121, v121 clamp
    v_max_f32_e64 v5, 0, v5
    v_cvt_pk_bf16_f32 v65, v2, v3
    v_pk_fma_f32 v[4:5], v[4:5], v[156:157], v[160:161] op_sel_hi:[1,0,0]
    v_pk_add_f32 v[4:5], v[4:5], v[120:121]
    v_pk_mul_f32 v[122:123], v[6:7], v[158:159] op_sel_hi:[1,0]
    v_max_f32_e64 v6, 0, v6
    v_exp_f32 v122, v122 clamp
    v_exp_f32 v123, v123 clamp
    v_max_f32_e64 v7, 0, v7
    v_cvt_pk_bf16_f32 v66, v4, v5
    v_pk_fma_f32 v[6:7], v[6:7], v[156:157], v[160:161] op_sel_hi:[1,0,0]
    v_pk_add_f32 v[6:7], v[6:7], v[122:123]
    v_pk_mul_f32 v[120:121], v[8:9], v[158:159] op_sel_hi:[1,0]
    v_max_f32_e64 v8, 0, v8
    v_exp_f32 v120, v120 clamp
    v_exp_f32 v121, v121 clamp
    v_max_f32_e64 v9, 0, v9
    v_cvt_pk_bf16_f32 v67, v6, v7
    v_pk_fma_f32 v[8:9], v[8:9], v[156:157], v[160:161] op_sel_hi:[1,0,0]
    v_pk_add_f32 v[8:9], v[8:9], v[120:121]
    v_pk_mul_f32 v[122:123], v[10:11], v[158:159] op_sel_hi:[1,0]
    v_max_f32_e64 v10, 0, v10
    v_exp_f32 v122, v122 clamp
    v_exp_f32 v123, v123 clamp
    v_max_f32_e64 v11, 0, v11
    v_cvt_pk_bf16_f32 v68, v8, v9
    v_pk_fma_f32 v[10:11], v[10:11], v[156:157], v[160:161] op_sel_hi:[1,0,0]
    v_pk_add_f32 v[10:11], v[10:11], v[122:123]
    buffer_load_dwordx4 v[80:83], v169, s[24:27], s40 offen offset:0 sc1
    buffer_load_dwordx4 v[84:87], v169, s[24:27], s40 offen offset:2048 sc1
    v_pk_mul_f32 v[120:121], v[12:13], v[158:159] op_sel_hi:[1,0]
    v_max_f32_e64 v12, 0, v12
    v_exp_f32 v120, v120 clamp
    v_exp_f32 v121, v121 clamp
    v_max_f32_e64 v13, 0, v13
    v_cvt_pk_bf16_f32 v69, v10, v11
    v_pk_fma_f32 v[12:13], v[12:13], v[156:157], v[160:161] op_sel_hi:[1,0,0]
    v_pk_add_f32 v[12:13], v[12:13], v[120:121]
    buffer_load_dwordx4 v[88:91], v169, s[24:27], s41 offen offset:0 sc1
    buffer_load_dwordx4 v[92:95], v169, s[24:27], s41 offen offset:2048 sc1
    v_pk_mul_f32 v[122:123], v[14:15], v[158:159] op_sel_hi:[1,0]
    v_max_f32_e64 v14, 0, v14
    v_exp_f32 v122, v122 clamp
    v_exp_f32 v123, v123 clamp
    v_max_f32_e64 v15, 0, v15
    v_cvt_pk_bf16_f32 v70, v12, v13
    v_pk_fma_f32 v[14:15], v[14:15], v[156:157], v[160:161] op_sel_hi:[1,0,0]
    v_pk_add_f32 v[14:15], v[14:15], v[122:123]
    buffer_load_dwordx4 v[96:99], v169, s[24:27], s42 offen offset:0 sc1
    buffer_load_dwordx4 v[100:103], v169, s[24:27], s42 offen offset:2048 sc1
    v_pk_mul_f32 v[120:121], v[16:17], v[158:159] op_sel_hi:[1,0]
    v_max_f32_e64 v16, 0, v16
    v_exp_f32 v120, v120 clamp
    v_exp_f32 v121, v121 clamp
    v_max_f32_e64 v17, 0, v17
    v_cvt_pk_bf16_f32 v71, v14, v15
    v_pk_fma_f32 v[16:17], v[16:17], v[156:157], v[160:161] op_sel_hi:[1,0,0]
    v_pk_add_f32 v[16:17], v[16:17], v[120:121]
    buffer_load_dwordx4 v[104:107], v169, s[24:27], s43 offen offset:0 sc1
    buffer_load_dwordx4 v[108:111], v169, s[24:27], s43 offen offset:2048 sc1
    v_pk_mul_f32 v[122:123], v[18:19], v[158:159] op_sel_hi:[1,0]
    v_max_f32_e64 v18, 0, v18
    v_exp_f32 v122, v122 clamp
    v_exp_f32 v123, v123 clamp
    v_max_f32_e64 v19, 0, v19
    v_cvt_pk_bf16_f32 v72, v16, v17
    v_pk_fma_f32 v[18:19], v[18:19], v[156:157], v[160:161] op_sel_hi:[1,0,0]
    v_pk_add_f32 v[18:19], v[18:19], v[122:123]
    v_cvt_pk_bf16_f32 v73, v18, v19
    v_permlane32_swap_b32 v64, v68
    v_permlane32_swap_b32 v65, v69
    v_permlane32_swap_b32 v66, v70
    v_permlane32_swap_b32 v67, v71
    s_mov_b32 s36, 0x40000
    s_mov_b32 s37, 0x3f80
    s_mov_b32 s38, 0x3f800000
    s_waitcnt vmcnt(7)
    v_max3_u32 v112, v80, v81, 0
    v_dot2_f32_bf16 v148, v80, s37, 0
    v_dot2_f32_bf16 v149, v80, s38, 0
    v_dot2_f32_bf16 v150, v81, s37, 0
    v_dot2_f32_bf16 v151, v81, s38, 0
    v_max3_u32 v112, v82, v83, v112
    v_dot2_f32_bf16 v152, v82, s37, 0
    v_dot2_f32_bf16 v153, v82, s38, 0
    v_dot2_f32_bf16 v154, v83, s37, 0
    v_dot2_f32_bf16 v155, v83, s38, 0
    s_waitcnt vmcnt(6)
    v_max3_u32 v112, v84, v85, v112
    v_dot2_f32_bf16 v148, v84, s37, v148
    v_dot2_f32_bf16 v149, v84, s38, v149
    v_dot2_f32_bf16 v150, v85, s37, v150
    v_dot2_f32_bf16 v151, v85, s38, v151
    v_max3_u32 v112, v86, v87, v112
    v_dot2_f32_bf16 v152, v86, s37, v152
    v_dot2_f32_bf16 v153, v86, s38, v153
    v_dot2_f32_bf16 v154, v87, s37, v154
    v_dot2_f32_bf16 v155, v87, s38, v155
    s_waitcnt vmcnt(5)
    v_max3_u32 v112, v88, v89, v112
    v_dot2_f32_bf16 v148, v88, s37, v148
    v_dot2_f32_bf16 v149, v88, s38, v149
    v_dot2_f32_bf16 v150, v89, s37, v150
    v_dot2_f32_bf16 v151, v89, s38, v151
    v_max3_u32 v112, v90, v91, v112
    v_dot2_f32_bf16 v152, v90, s37, v152
    v_dot2_f32_bf16 v153, v90, s38, v153
    v_dot2_f32_bf16 v154, v91, s37, v154
    v_dot2_f32_bf16 v155, v91, s38, v155
    s_waitcnt vmcnt(4)
    v_max3_u32 v112, v92, v93, v112
    v_dot2_f32_bf16 v148, v92, s37, v148
    v_dot2_f32_bf16 v149, v92, s38, v149
    v_dot2_f32_bf16 v150, v93, s37, v150
    v_dot2_f32_bf16 v151, v93, s38, v151
    v_max3_u32 v112, v94, v95, v112
    v_dot2_f32_bf16 v152, v94, s37, v152
    v_dot2_f32_bf16 v153, v94, s38, v153
    v_dot2_f32_bf16 v154, v95, s37, v154
    v_dot2_f32_bf16 v155, v95, s38, v155
    s_waitcnt vmcnt(3)
    v_max3_u32 v112, v96, v97, v112
    v_dot2_f32_bf16 v148, v96, s37, v148
    v_dot2_f32_bf16 v149, v96, s38, v149
    v_dot2_f32_bf16 v150, v97, s37, v150
    v_dot2_f32_bf16 v151, v97, s38, v151
    v_max3_u32 v112, v98, v99, v112
    v_dot2_f32_bf16 v152, v98, s37, v152
    v_dot2_f32_bf16 v153, v98, s38, v153
    v_dot2_f32_bf16 v154, v99, s37, v154
    v_dot2_f32_bf16 v155, v99, s38, v155
    s_waitcnt vmcnt(2)
    v_max3_u32 v112, v100, v101, v112
    v_dot2_f32_bf16 v148, v100, s37, v148
    v_dot2_f32_bf16 v149, v100, s38, v149
    v_dot2_f32_bf16 v150, v101, s37, v150
    v_dot2_f32_bf16 v151, v101, s38, v151
    v_max3_u32 v112, v102, v103, v112
    v_dot2_f32_bf16 v152, v102, s37, v152
    v_dot2_f32_bf16 v153, v102, s38, v153
    v_dot2_f32_bf16 v154, v103, s37, v154
    v_dot2_f32_bf16 v155, v103, s38, v155
    s_waitcnt vmcnt(1)
    v_max3_u32 v112, v104, v105, v112
    v_dot2_f32_bf16 v148, v104, s37, v148
    v_dot2_f32_bf16 v149, v104, s38, v149
    v_dot2_f32_bf16 v150, v105, s37, v150
    v_dot2_f32_bf16 v151, v105, s38, v151
    v_max3_u32 v112, v106, v107, v112
    v_dot2_f32_bf16 v152, v106, s37, v152
    v_dot2_f32_bf16 v153, v106, s38, v153
    v_dot2_f32_bf16 v154, v107, s37, v154
    v_dot2_f32_bf16 v155, v107, s38, v155
    s_waitcnt vmcnt(0)
    v_max3_u32 v112, v108, v109, v112
    v_dot2_f32_bf16 v148, v108, s37, v148
    v_dot2_f32_bf16 v149, v108, s38, v149
    v_dot2_f32_bf16 v150, v109, s37, v150
    v_dot2_f32_bf16 v151, v109, s38, v151
    v_max3_u32 v112, v110, v111, v112
    v_cmp_eq_u32 vcc, -1, v112
    v_dot2_f32_bf16 v152, v110, s37, v152
    v_dot2_f32_bf16 v153, v110, s38, v153
    v_dot2_f32_bf16 v154, v111, s37, v154
    v_dot2_f32_bf16 v155, v111, s38, v155
    s_cbranch_vccz L_m_qgot
L_m_qpoll:
    buffer_load_dwordx4 v[80:83], v169, s[24:27], s40 offen offset:0 sc1
    buffer_load_dwordx4 v[84:87], v169, s[24:27], s40 offen offset:2048 sc1
    buffer_load_dwordx4 v[88:91], v169, s[24:27], s41 offen offset:0 sc1
    buffer_load_dwordx4 v[92:95], v169, s[24:27], s41 offen offset:2048 sc1
    buffer_load_dwordx4 v[96:99], v169, s[24:27], s42 offen offset:0 sc1
    buffer_load_dwordx4 v[100:103], v169, s[24:27], s42 offen offset:2048 sc1
    buffer_load_dwordx4 v[104:107], v169, s[24:27], s43 offen offset:0 sc1
    buffer_load_dwordx4 v[108:111], v169, s[24:27], s43 offen offset:2048 sc1
    s_sub_u32 s36, s36, 1
    s_waitcnt vmcnt(7)
    v_max3_u32 v112, v80, v81, 0
    v_dot2_f32_bf16 v148, v80, s37, 0
    v_dot2_f32_bf16 v149, v80, s38, 0
    v_dot2_f32_bf16 v150, v81, s37, 0
    v_dot2_f32_bf16 v151, v81, s38, 0
    v_max3_u32 v112, v82, v83, v112
    v_dot2_f32_bf16 v152, v82, s37, 0
    v_dot2_f32_bf16 v153, v82, s38, 0
    v_dot2_f32_bf16 v154, v83, s37, 0
    v_dot2_f32_bf16 v155, v83, s38, 0
    s_waitcnt vmcnt(6)
    v_max3_u32 v112, v84, v85, v112
    v_dot2_f32_bf16 v148, v84, s37, v148
    v_dot2_f32_bf16 v149, v84, s38, v149
    v_dot2_f32_bf16 v150, v85, s37, v150
    v_dot2_f32_bf16 v151, v85, s38, v151
    v_max3_u32 v112, v86, v87, v112
    v_dot2_f32_bf16 v152, v86, s37, v152
    v_dot2_f32_bf16 v153, v86, s38, v153
    v_dot2_f32_bf16 v154, v87, s37, v154
    v_dot2_f32_bf16 v155, v87, s38, v155
    s_waitcnt vmcnt(5)
    v_max3_u32 v112, v88, v89, v112
    v_dot2_f32_bf16 v148, v88, s37, v148
    v_dot2_f32_bf16 v149, v88, s38, v149
    v_dot2_f32_bf16 v150, v89, s37, v150
    v_dot2_f32_bf16 v151, v89, s38, v151
    v_max3_u32 v112, v90, v91, v112
    v_dot2_f32_bf16 v152, v90, s37, v152
    v_dot2_f32_bf16 v153, v90, s38, v153
    v_dot2_f32_bf16 v154, v91, s37, v154
    v_dot2_f32_bf16 v155, v91, s38, v155
    s_waitcnt vmcnt(4)
    v_max3_u32 v112, v92, v93, v112
    v_dot2_f32_bf16 v148, v92, s37, v148
    v_dot2_f32_bf16 v149, v92, s38, v149
    v_dot2_f32_bf16 v150, v93, s37, v150
    v_dot2_f32_bf16 v151, v93, s38, v151
    v_max3_u32 v112, v94, v95, v112
    v_dot2_f32_bf16 v152, v94, s37, v152
    v_dot2_f32_bf16 v153, v94, s38, v153
    v_dot2_f32_bf16 v154, v95, s37, v154
    v_dot2_f32_bf16 v155, v95, s38, v155
    s_waitcnt vmcnt(3)
    v_max3_u32 v112, v96, v97, v112
    v_dot2_f32_bf16 v148, v96, s37, v148
    v_dot2_f32_bf16 v149, v96, s38, v149
    v_dot2_f32_bf16 v150, v97, s37, v150
    v_dot2_f32_bf16 v151, v97, s38, v151
    v_max3_u32 v112, v98, v99, v112
    v_dot2_f32_bf16 v152, v98, s37, v152
    v_dot2_f32_bf16 v153, v98, s38, v153
    v_dot2_f32_bf16 v154, v99, s37, v154
    v_dot2_f32_bf16 v155, v99, s38, v155
    s_waitcnt vmcnt(2)
    v_max3_u32 v112, v100, v101, v112
    v_dot2_f32_bf16 v148, v100, s37, v148
    v_dot2_f32_bf16 v149, v100, s38, v149
    v_dot2_f32_bf16 v150, v101, s37, v150
    v_dot2_f32_bf16 v151, v101, s38, v151
    v_max3_u32 v112, v102, v103, v112
    v_dot2_f32_bf16 v152, v102, s37, v152
    v_dot2_f32_bf16 v153, v102, s38, v153
    v_dot2_f32_bf16 v154, v103, s37, v154
    v_dot2_f32_bf16 v155, v103, s38, v155
    s_waitcnt vmcnt(1)
    v_max3_u32 v112, v104, v105, v112
    v_dot2_f32_bf16 v148, v104, s37, v148
    v_dot2_f32_bf16 v149, v104, s38, v149
    v_dot2_f32_bf16 v150, v105, s37, v150
    v_dot2_f32_bf16 v151, v105, s38, v151
    v_max3_u32 v112, v106, v107, v112
    v_dot2_f32_bf16 v152, v106, s37, v152
    v_dot2_f32_bf16 v153, v106, s38, v153
    v_dot2_f32_bf16 v154, v107, s37, v154
    v_dot2_f32_bf16 v155, v107, s38, v155
    s_waitcnt vmcnt(0)
    v_max3_u32 v112, v108, v109, v112
    v_dot2_f32_bf16 v148, v108, s37, v148
    v_dot2_f32_bf16 v149, v108, s38, v149
    v_dot2_f32_bf16 v150, v109, s37, v150
    v_dot2_f32_bf16 v151, v109, s38, v151
    v_max3_u32 v112, v110, v111, v112
    v_cmp_eq_u32 vcc, -1, v112
    v_dot2_f32_bf16 v152, v110, s37, v152
    v_dot2_f32_bf16 v153, v110, s38, v153
    v_dot2_f32_bf16 v154, v111, s37, v154
    v_dot2_f32_bf16 v155, v111, s38, v155
    s_cmp_eq_u32 s36, 0
    s_cbranch_scc1 L_m_qgot
    s_cbranch_vccnz L_m_qpoll
L_m_qgot:
    s_nop 3
    v_permlane32_swap_b32 v148, v152
    v_permlane32_swap_b32 v149, v153
    v_permlane32_swap_b32 v150, v154
    v_permlane32_swap_b32 v151, v155
    v_pk_add_f32 v[148:149], v[148:149], v[152:153]
    v_pk_add_f32 v[150:151], v[150:151], v[154:155]
    v_cvt_pk_bf16_f32 v152, v148, v149
    v_cvt_pk_bf16_f32 v153, v150, v151
    ds_write_b64 v170, v[152:153] offset:24576
    s_waitcnt lgkmcnt(0)
    s_barrier
    ds_read_b64 v[88:89], v172 offset:25920
    ds_read_b128 v[80:83], v171 offset:24576
    ds_read_b128 v[84:87], v171 offset:25248
    s_waitcnt lgkmcnt(2)
    v_mfma_f32_32x32x4_2b_bf16 v[0:31], v[88:89], v[72:73], 0
    s_waitcnt lgkmcnt(0)
    s_nop 15
    s_nop 0
    v_mfma_f32_32x32x16_bf16 v[0:15], v[80:83], v[64:67], v[0:15]
    v_mfma_f32_32x32x16_bf16 v[16:31], v[84:87], v[68:71], v[16:31]
    s_nop 10
    v_add_f32 v12, v160, v12
    v_rcp_f32_e64 v156, v12
    s_nop 0
    v_pk_mul_f32 v[0:1], v[0:1], v[156:157] op_sel_hi:[1,0]
    v_pk_mul_f32 v[2:3], v[2:3], v[156:157] op_sel_hi:[1,0]
    v_cvt_pk_bf16_f32 v40, v0, v1
    v_pk_mul_f32 v[4:5], v[4:5], v[156:157] op_sel_hi:[1,0]
    v_cvt_pk_bf16_f32 v41, v2, v3
    v_pk_mul_f32 v[6:7], v[6:7], v[156:157] op_sel_hi:[1,0]
    v_cvt_pk_bf16_f32 v42, v4, v5
    v_pk_mul_f32 v[8:9], v[8:9], v[156:157] op_sel_hi:[1,0]
    v_cvt_pk_bf16_f32 v43, v6, v7
    v_pk_mul_f32 v[10:11], v[10:11], v[156:157] op_sel_hi:[1,0]
    v_cvt_pk_bf16_f32 v44, v8, v9
    v_cvt_pk_bf16_f32 v45, v10, v11
    buffer_store_dwordx4 v[40:43], v253, s[24:27], s32 offen offset:0 sc1
    v_add_f32 v28, v160, v28
    v_rcp_f32_e64 v156, v28
    s_nop 0
    v_pk_mul_f32 v[16:17], v[16:17], v[156:157] op_sel_hi:[1,0]
    v_pk_mul_f32 v[18:19], v[18:19], v[156:157] op_sel_hi:[1,0]
    v_cvt_pk_bf16_f32 v46, v16, v17
    v_pk_mul_f32 v[20:21], v[20:21], v[156:157] op_sel_hi:[1,0]
    v_cvt_pk_bf16_f32 v47, v18, v19
    v_pk_mul_f32 v[22:23], v[22:23], v[156:157] op_sel_hi:[1,0]
    v_cvt_pk_bf16_f32 v48, v20, v21
    v_pk_mul_f32 v[24:25], v[24:25], v[156:157] op_sel_hi:[1,0]
    v_cvt_pk_bf16_f32 v49, v22, v23
    v_pk_mul_f32 v[26:27], v[26:27], v[156:157] op_sel_hi:[1,0]
    v_cvt_pk_bf16_f32 v50, v24, v25
    v_cvt_pk_bf16_f32 v51, v26, v27
    buffer_store_dwordx4 v[46:49], v253, s[24:27], s32 offen offset:1024 sc1
    v_mov_b32 v52, v44
    v_mov_b32 v53, v45
    v_mov_b32 v54, v50
    v_mov_b32 v55, v51
    buffer_store_dwordx4 v[52:55], v173, s[24:27], s33 offen sc1
    s_lshl_b32 s60, s96, 4
    s_add_u32 s60, s60, s7
    s_lshl_b32 s60, s60, 4
    s_add_u32 s60, s60, s6
    s_lshl_b32 s60, s60, 5
    s_add_u32 s60, s60, 0x78e000
L_m_otop:
    s_bitcmp0_b32 s97, 0
    s_cselect_b32 s17, 0x280000, 0x0
    s_and_b32 s48, s2, 3
    s_lshl_b32 s48, s48, 2
    s_bfe_u32 s49, s2, 0x20003
    s_add_u32 s48, s48, s49
    s_bfe_u32 s49, s2, 0x10002
    s_lshl_b32 s49, s49, 3
    s_lshr_b32 s50, s2, 5
    s_add_u32 s49, s49, s50
    s_mul_i32 s48, s48, 163840
    s_add_u32 s17, s17, s48
    s_lshl_b32 s49, s3, 12
    s_add_u32 s8, s4, s17
    s_addc_u32 s9, s5, 0
    s_mov_b32 s10, 0x28000
    s_mov_b32 s11, 0x20000
    s_bfe_u32 s6, s2, 0x30003
    s_and_b32 s7, s2, 7
    s_lshl_b32 s7, s7, 2
    s_lshr_b32 s16, s2, 6
    s_add_u32 s7, s7, s16
    s_and_b32 s34, s3, 1
    s_lshr_b32 s35, s3, 1
    s_lshl_b32 s16, s7, 1
    s_add_u32 s16, s16, s34
    s_mul_i32 s36, s16, 40960
    s_mul_i32 s18, s97, 2621440
    s_add_u32 s18, s18, s36
    s_add_u32 s18, s18, 0x1278000
    s_mul_i32 s21, s35, 20480
    s_lshr_b32 s46, s7, 1
    s_and_b32 s47, s7, 1
    s_lshl_b32 s47, s47, 3
    s_add_u32 s47, s47, s6
    s_add_u32 s12, s4, s18
    s_addc_u32 s13, s5, 0
    s_mov_b32 s14, 0xa000
    s_mov_b32 s15, 0x20000
    s_lshl_b32 s22, s96, 4
    s_add_u32 s22, s22, s46
    s_lshl_b32 s22, s22, 2
    s_add_u32 s22, s22, s3
    s_lshl_b32 s22, s22, 7
    s_add_u32 s22, s22, 0x78e000
    v_lshlrev_b32 v187, 5, v252
    s_cmp_lg_u32 s3, 0
    s_waitcnt vmcnt(0)
    s_barrier
    s_cbranch_scc1 L_m_pub2169
    s_mov_b64 exec, 1
    buffer_store_dwordx2 v[254:255], off, s[56:59], s60 sc1
    s_mov_b64 exec, -1
L_m_pub2169:
    s_add_u32 s96, s96, 1
    s_cmp_eq_u32 s97, 3
    s_cselect_b32 s10, 0, s10
    s_cbranch_scc1 L_m_onopre
    s_add_u32 s50, s49, 0
    s_mov_b32 m0, s50
    s_nop 0
    buffer_load_dwordx4 v253, s[8:11], s50 offen offset:0 sc1 lds
    buffer_load_dwordx4 v253, s[8:11], s50 offen offset:1024 sc1 lds
    buffer_load_dwordx4 v253, s[8:11], s50 offen offset:2048 sc1 lds
    buffer_load_dwordx4 v253, s[8:11], s50 offen offset:3072 sc1 lds
    s_add_u32 s50, s49, 16384
    s_mov_b32 m0, s50
    s_nop 0
    buffer_load_dwordx4 v253, s[8:11], s50 offen offset:0 sc1 lds
    buffer_load_dwordx4 v253, s[8:11], s50 offen offset:1024 sc1 lds
    buffer_load_dwordx4 v253, s[8:11], s50 offen offset:2048 sc1 lds
    buffer_load_dwordx4 v253, s[8:11], s50 offen offset:3072 sc1 lds
L_m_onopre:
    s_mul_i32 s23, s35, 51200
    s_add_u32 s23, s23, 61440
    v_add_u32 v180, s23, v253
    s_lshl_b32 s23, s35, 10
    v_add_u32_e64 v179, s23, v180
    s_xor_b32 s23, s23, 1024
    v_add_u32 v178, s23, v180
    v_lshrrev_b32 v186, 1, v253
    v_xor_b32 v186, v186, v253
    v_and_b32 v186, 64, v186
    v_mul_u32_u24 v186, 3, v186
    v_xor_b32 v180, v186, v180
    s_mul_i32 s37, s6, 5
    s_lshl_b32 s38, s35, 1
    s_add_u32 s38, s38, s37
    s_add_u32 s37, s37, 4
    s_mul_i32 s23, s3, 6144
    s_add_u32 s23, s23, 61440
    v_add_u32 v181, s23, v253
    s_xor_b32 s23, s3, 2
    s_mul_i32 s23, s23, 6144
    s_add_u32 s23, s23, 61440
    v_add_u32_e64 v182, s23, v253
    s_mov_b32 s42, 0x3f80
    s_mov_b32 s43, 0x3f800000
    s_lshl_b32 s41, s35, 30
    s_cmp_eq_u32 s35, 0
    s_cselect_b32 s45, s43, 0
    s_cselect_b64 s[24:25], -1, 1
    s_cselect_b64 s[26:27], 1, -1
    v_and_b32_e64 v186, 31, v252
    s_mov_b32 s31, 0x20000
    s_cmp_eq_u32 s97, 3
    s_cbranch_scc1 L_m_ofin
    s_mul_i32 s33, s16, 43008
    s_mul_i32 s20, s97, 2752512
    s_add_u32 s20, s20, s33
    s_add_u32 s20, s20, 0xa98000
    s_add_u32 s28, s4, s20
    s_addc_u32 s29, s5, 0
    s_mov_b32 s30, 43008
    v_mov_b32 v183, v253
    v_lshlrev_b32 v185, 2, v186
    s_lshl_b32 s39, s38, 10
    s_add_u32 s44, s39, 1024
    s_lshl_b32 s40, s37, 10
    s_lshl_b32 s32, s6, 1
    s_add_u32 s32, s32, s35
    s_lshl_b32 s32, s32, 7
    s_add_u32 s32, s32, 40960
    s_branch L_m_ogo
L_m_ofin:
    s_mov_b64 s[28:29], s[98:99]
    s_mov_b32 s30, 2621440
    v_mul_u32_u24 v183, 1280, v186
    v_lshrrev_b32_e64 v186, 5, v252
    v_lshl_add_u32 v183, v186, 4, v183
    v_mov_b32 v185, 0x40000000
    s_lshl_b32 s39, s38, 5
    s_add_u32 s39, s39, s36
    s_add_u32 s44, s39, 32
    s_lshl_b32 s40, s37, 5
    s_add_u32 s40, s40, s36
    s_mov_b32 s32, 0
L_m_ogo:
    v_add_u32 v184, s41, v183
    ds_read_b128 a[52:55], v180 offset:4096
    ds_read_b128 a[56:59], v178 offset:0
    ds_read_b128 a[60:63], v179 offset:0
    ds_read_b128 a[64:67], v178 offset:2048
    ds_read_b128 a[68:71], v179 offset:2048
    ds_read_b128 a[72:75], v180 offset:9216
    ds_read_b128 a[76:79], v178 offset:5120
    ds_read_b128 a[80:83], v179 offset:5120
    ds_read_b128 a[84:87], v178 offset:7168
    ds_read_b128 a[88:91], v179 offset:7168
    ds_read_b128 a[92:95], v180 offset:14336
    ds_read_b128 a[96:99], v178 offset:10240
    ds_read_b128 a[100:103], v179 offset:10240
    ds_read_b128 a[104:107], v178 offset:12288
    ds_read_b128 a[108:111], v179 offset:12288
    ds_read_b128 a[112:115], v180 offset:19456
    ds_read_b128 a[116:119], v178 offset:15360
    ds_read_b128 a[120:123], v179 offset:15360
    ds_read_b128 a[124:127], v178 offset:17408
    ds_read_b128 a[128:131], v179 offset:17408
    ds_read_b128 a[132:135], v180 offset:24576
    ds_read_b128 a[136:139], v178 offset:20480
    ds_read_b128 a[140:143], v179 offset:20480
    ds_read_b128 a[144:147], v178 offset:22528
    ds_read_b128 a[148:151], v179 offset:22528
    ds_read_b128 v[144:147], v180 offset:29696
    ds_read_b128 v[148:151], v178 offset:25600
    ds_read_b128 v[152:155], v179 offset:25600
    ds_read_b128 v[156:159], v178 offset:27648
    ds_read_b128 v[160:163], v179 offset:27648
    v_lshlrev_b32_e64 v16, 16, v240
    v_and_b32 v17, 0xffff0000, v240
    v_lshlrev_b32_e64 v18, 16, v241
    v_and_b32 v19, 0xffff0000, v241
    v_lshlrev_b32_e64 v20, 16, v242
    v_and_b32 v21, 0xffff0000, v242
    v_lshlrev_b32_e64 v22, 16, v243
    v_and_b32 v23, 0xffff0000, v243
    v_lshlrev_b32_e64 v24, 16, v244
    v_and_b32 v25, 0xffff0000, v244
    v_lshlrev_b32_e64 v26, 16, v245
    v_and_b32 v27, 0xffff0000, v245
    v_lshlrev_b32_e64 v28, 16, v246
    v_and_b32 v29, 0xffff0000, v246
    v_lshlrev_b32_e64 v30, 16, v247
    v_and_b32 v31, 0xffff0000, v247
    s_mov_b32 s23, 0x40000
    s_mov_b64 exec, 15
    .p2align 5
L_m_poll2313:
    buffer_load_dwordx2 v[188:189], v187, s[56:59], s22 offen sc1
    s_sub_u32 s23, s23, 1
    s_cbranch_scc1 L_m_poll2313x
    s_waitcnt vmcnt(0)
    v_cmp_ne_u64 vcc, s[100:101], v[188:189]
    s_and_b64 exec, vcc, vcc
    s_cbranch_scc1 L_m_poll2313
L_m_poll2313x:
    s_mov_b64 exec, -1
    s_waitcnt lgkmcnt(0)
    s_barrier
    buffer_load_dwordx4 v[64:67], v253, s[12:15], s21 offen offset:0 sc1
    buffer_load_dwordx4 v[68:71], v253, s[12:15], s21 offen offset:1024 sc1
    buffer_load_dwordx4 v[72:75], v253, s[12:15], s21 offen offset:2048 sc1
    buffer_load_dwordx4 v[76:79], v253, s[12:15], s21 offen offset:3072 sc1
    s_add_u32 s21, s21, 4096
    buffer_load_dwordx4 v[80:83], v253, s[12:15], s21 offen offset:0 sc1
    buffer_load_dwordx4 v[84:87], v253, s[12:15], s21 offen offset:1024 sc1
    buffer_load_dwordx4 v[88:91], v253, s[12:15], s21 offen offset:2048 sc1
    buffer_load_dwordx4 v[92:95], v253, s[12:15], s21 offen offset:3072 sc1
    s_add_u32 s21, s21, 4096
    buffer_load_dwordx4 v[96:99], v253, s[12:15], s21 offen offset:0 sc1
    buffer_load_dwordx4 v[100:103], v253, s[12:15], s21 offen offset:1024 sc1
    buffer_load_dwordx4 v[104:107], v253, s[12:15], s21 offen offset:2048 sc1
    buffer_load_dwordx4 v[108:111], v253, s[12:15], s21 offen offset:3072 sc1
    s_waitcnt vmcnt(11)
    v_mfma_f32_32x32x16_bf16 v[0:15], a[56:59], v[64:67], 0
    ds_read_b128 a[56:59], v178 offset:30720
    s_add_u32 s21, s21, 4096
    buffer_load_dwordx4 v[112:115], v253, s[12:15], s21 offen offset:0 sc1
    v_mfma_f32_32x32x16_bf16 v[16:31], a[60:63], v[64:67], v[16:31]
    ds_read_b128 a[60:63], v179 offset:30720
    s_waitcnt vmcnt(11)
    v_mfma_f32_32x32x16_bf16 v[0:15], a[64:67], v[68:71], v[0:15]
    ds_read_b128 a[64:67], v178 offset:32768
    buffer_load_dwordx4 v[116:119], v253, s[12:15], s21 offen offset:1024 sc1
    v_mfma_f32_32x32x16_bf16 v[16:31], a[68:71], v[68:71], v[16:31]
    ds_read_b128 a[68:71], v179 offset:32768
    v_permlane16_swap_b32 v64, v68
    v_permlane16_swap_b32 v65, v69
    v_permlane16_swap_b32 v66, v70
    v_permlane16_swap_b32 v67, v71
    s_nop 1
    v_mfma_f32_16x16x32_bf16 v[32:35], a[52:55], v[64:67], 0
    v_mfma_f32_16x16x32_bf16 v[36:39], a[52:55], v[68:71], 0
    ds_read_b128 a[52:55], v180 offset:34816
    s_waitcnt vmcnt(11)
    v_mfma_f32_32x32x16_bf16 v[0:15], a[76:79], v[72:75], v[0:15]
    ds_read_b128 a[76:79], v178 offset:35840
    buffer_load_dwordx4 v[120:123], v253, s[12:15], s21 offen offset:2048 sc1
    v_mfma_f32_32x32x16_bf16 v[16:31], a[80:83], v[72:75], v[16:31]
    ds_read_b128 a[80:83], v179 offset:35840
    s_waitcnt vmcnt(11)
    v_mfma_f32_32x32x16_bf16 v[0:15], a[84:87], v[76:79], v[0:15]
    ds_read_b128 a[84:87], v178 offset:37888
    buffer_load_dwordx4 v[124:127], v253, s[12:15], s21 offen offset:3072 sc1
    v_mfma_f32_32x32x16_bf16 v[16:31], a[88:91], v[76:79], v[16:31]
    ds_read_b128 a[88:91], v179 offset:37888
    v_permlane16_swap_b32 v72, v76
    v_permlane16_swap_b32 v73, v77
    v_permlane16_swap_b32 v74, v78
    v_permlane16_swap_b32 v75, v79
    s_nop 1
    v_mfma_f32_16x16x32_bf16 v[32:35], a[72:75], v[72:75], v[32:35]
    v_mfma_f32_16x16x32_bf16 v[36:39], a[72:75], v[76:79], v[36:39]
    ds_read_b128 a[72:75], v180 offset:39936
    s_waitcnt vmcnt(11)
    v_mfma_f32_32x32x16_bf16 v[0:15], a[96:99], v[80:83], v[0:15]
    ds_read_b128 a[96:99], v178 offset:40960
    s_add_u32 s21, s21, 4096
    buffer_load_dwordx4 v[128:131], v253, s[12:15], s21 offen offset:0 sc1
    v_mfma_f32_32x32x16_bf16 v[16:31], a[100:103], v[80:83], v[16:31]
    ds_read_b128 a[100:103], v179 offset:40960
    s_waitcnt vmcnt(11)
    v_mfma_f32_32x32x16_bf16 v[0:15], a[104:107], v[84:87], v[0:15]
    ds_read_b128 a[104:107], v178 offset:43008
    buffer_load_dwordx4 v[132:135], v253, s[12:15], s21 offen offset:1024 sc1
    v_mfma_f32_32x32x16_bf16 v[16:31], a[108:111], v[84:87], v[16:31]
    ds_read_b128 a[108:111], v179 offset:43008
    v_permlane16_swap_b32 v80, v84
    v_permlane16_swap_b32 v81, v85
    v_permlane16_swap_b32 v82, v86
    v_permlane16_swap_b32 v83, v87
    s_nop 1
    v_mfma_f32_16x16x32_bf16 v[32:35], a[92:95], v[80:83], v[32:35]
    v_mfma_f32_16x16x32_bf16 v[36:39], a[92:95], v[84:87], v[36:39]
    ds_read_b128 a[92:95], v180 offset:45056
    s_waitcnt vmcnt(11)
    v_mfma_f32_32x32x16_bf16 v[0:15], a[116:119], v[88:91], v[0:15]
    ds_read_b128 a[116:119], v178 offset:46080
    buffer_load_dwordx4 v[136:139], v253, s[12:15], s21 offen offset:2048 sc1
    v_mfma_f32_32x32x16_bf16 v[16:31], a[120:123], v[88:91], v[16:31]
    ds_read_b128 a[120:123], v179 offset:46080
    s_waitcnt vmcnt(11)
    v_mfma_f32_32x32x16_bf16 v[0:15], a[124:127], v[92:95], v[0:15]
    ds_read_b128 a[124:127], v178 offset:48128
    buffer_load_dwordx4 v[140:143], v253, s[12:15], s21 offen offset:3072 sc1
    v_mfma_f32_32x32x16_bf16 v[16:31], a[128:131], v[92:95], v[16:31]
    ds_read_b128 a[128:131], v179 offset:48128
    v_permlane16_swap_b32 v88, v92
    v_permlane16_swap_b32 v89, v93
    v_permlane16_swap_b32 v90, v94
    v_permlane16_swap_b32 v91, v95
    s_nop 1
    v_mfma_f32_16x16x32_bf16 v[32:35], a[112:115], v[88:91], v[32:35]
    v_mfma_f32_16x16x32_bf16 v[36:39], a[112:115], v[92:95], v[36:39]
    ds_read_b128 a[112:115], v180 offset:50176
    s_waitcnt vmcnt(11)
    v_mfma_f32_32x32x16_bf16 v[0:15], a[136:139], v[96:99], v[0:15]
    s_add_u32 s50, s49, 32768
    s_mov_b32 m0, s50
    s_nop 0
    buffer_load_dwordx4 v253, s[8:11], s50 offen offset:0 sc1 lds
    v_mfma_f32_32x32x16_bf16 v[16:31], a[140:143], v[96:99], v[16:31]
    s_waitcnt vmcnt(11)
    v_mfma_f32_32x32x16_bf16 v[0:15], a[144:147], v[100:103], v[0:15]
    buffer_load_dwordx4 v253, s[8:11], s50 offen offset:1024 sc1 lds
    v_mfma_f32_32x32x16_bf16 v[16:31], a[148:151], v[100:103], v[16:31]
    v_permlane16_swap_b32 v96, v100
    v_permlane16_swap_b32 v97, v101
    v_permlane16_swap_b32 v98, v102
    v_permlane16_swap_b32 v99, v103
    s_nop 1
    v_mfma_f32_16x16x32_bf16 v[32:35], a[132:135], v[96:99], v[32:35]
    v_mfma_f32_16x16x32_bf16 v[36:39], a[132:135], v[100:103], v[36:39]
    s_waitcnt vmcnt(11)
    v_mfma_f32_32x32x16_bf16 v[0:15], v[148:151], v[104:107], v[0:15]
    buffer_load_dwordx4 v253, s[8:11], s50 offen offset:2048 sc1 lds
    v_mfma_f32_32x32x16_bf16 v[16:31], v[152:155], v[104:107], v[16:31]
    s_waitcnt vmcnt(11)
    v_mfma_f32_32x32x16_bf16 v[0:15], v[156:159], v[108:111], v[0:15]
    buffer_load_dwordx4 v253, s[8:11], s50 offen offset:3072 sc1 lds
    v_mfma_f32_32x32x16_bf16 v[16:31], v[160:163], v[108:111], v[16:31]
    v_permlane16_swap_b32 v104, v108
    v_permlane16_swap_b32 v105, v109
    v_permlane16_swap_b32 v106, v110
    v_permlane16_swap_b32 v107, v111
    s_nop 1
    v_mfma_f32_16x16x32_bf16 v[32:35], v[144:147], v[104:107], v[32:35]
    v_mfma_f32_16x16x32_bf16 v[36:39], v[144:147], v[108:111], v[36:39]
    s_waitcnt vmcnt(11) lgkmcnt(0)
    v_mfma_f32_32x32x16_bf16 v[0:15], a[56:59], v[112:115], v[0:15]
    v_mfma_f32_32x32x16_bf16 v[16:31], a[60:63], v[112:115], v[16:31]
    s_waitcnt vmcnt(10)
    v_mfma_f32_32x32x16_bf16 v[0:15], a[64:67], v[116:119], v[0:15]
    v_mfma_f32_32x32x16_bf16 v[16:31], a[68:71], v[116:119], v[16:31]
    v_permlane16_swap_b32 v112, v116
    v_permlane16_swap_b32 v113, v117
    v_permlane16_swap_b32 v114, v118
    v_permlane16_swap_b32 v115, v119
    s_nop 1
    v_mfma_f32_16x16x32_bf16 v[32:35], a[52:55], v[112:115], v[32:35]
    v_mfma_f32_16x16x32_bf16 v[36:39], a[52:55], v[116:119], v[36:39]
    s_waitcnt vmcnt(9)
    v_mfma_f32_32x32x16_bf16 v[0:15], a[76:79], v[120:123], v[0:15]
    s_waitcnt vmcnt(8)
    v_mfma_f32_32x32x16_bf16 v[0:15], a[84:87], v[124:127], v[0:15]
    v_permlane16_swap_b32 v120, v124
    v_permlane16_swap_b32 v121, v125
    v_permlane16_swap_b32 v122, v126
    v_permlane16_swap_b32 v123, v127
    s_nop 1
    v_mfma_f32_16x16x32_bf16 v[32:35], a[72:75], v[120:123], v[32:35]
    v_mfma_f32_16x16x32_bf16 v[36:39], a[72:75], v[124:127], v[36:39]
    s_waitcnt vmcnt(7)
    v_mfma_f32_32x32x16_bf16 v[0:15], a[96:99], v[128:131], v[0:15]
    v_permlane16_swap_b32 v120, v124
    v_permlane16_swap_b32 v121, v125
    v_permlane16_swap_b32 v122, v126
    v_permlane16_swap_b32 v123, v127
    s_waitcnt vmcnt(6)
    v_mfma_f32_32x32x16_bf16 v[0:15], a[104:107], v[132:135], v[0:15]
    v_permlane16_swap_b32 v128, v132
    v_permlane16_swap_b32 v129, v133
    v_permlane16_swap_b32 v130, v134
    v_permlane16_swap_b32 v131, v135
    s_nop 1
    v_mfma_f32_16x16x32_bf16 v[32:35], a[92:95], v[128:131], v[32:35]
    v_mfma_f32_16x16x32_bf16 v[36:39], a[92:95], v[132:135], v[36:39]
    s_waitcnt vmcnt(5)
    v_mfma_f32_32x32x16_bf16 v[0:15], a[116:119], v[136:139], v[0:15]
    v_permlane16_swap_b32 v128, v132
    v_permlane16_swap_b32 v129, v133
    v_permlane16_swap_b32 v130, v134
    v_permlane16_swap_b32 v131, v135
    s_waitcnt vmcnt(4)
    v_mfma_f32_32x32x16_bf16 v[0:15], a[124:127], v[140:143], v[0:15]
    v_permlane16_swap_b32 v136, v140
    v_permlane16_swap_b32 v137, v141
    v_permlane16_swap_b32 v138, v142
    v_permlane16_swap_b32 v139, v143
    s_nop 1
    v_mfma_f32_16x16x32_bf16 v[32:35], a[112:115], v[136:139], v[32:35]
    v_mfma_f32_16x16x32_bf16 v[36:39], a[112:115], v[140:143], v[36:39]
    v_mfma_f32_32x32x16_bf16 v[16:31], a[80:83], v[120:123], v[16:31]
    s_nop 2
    ds_write_b128 v181, v[0:3] offset:0
    ds_write_b128 v181, v[4:7] offset:1024
    ds_write_b128 v181, v[8:11] offset:2048
    ds_write_b128 v181, v[12:15] offset:3072
    v_mfma_f32_32x32x16_bf16 v[16:31], a[88:91], v[124:127], v[16:31]
    v_permlane16_swap_b32 v32, v36
    v_permlane16_swap_b32 v33, v37
    v_permlane16_swap_b32 v34, v38
    v_permlane16_swap_b32 v35, v39
    ds_write_b128 v181, v[32:35] offset:4096
    ds_write_b128 v181, v[36:39] offset:5120
    v_mfma_f32_32x32x16_bf16 v[16:31], a[100:103], v[128:131], v[16:31]
    v_permlane16_swap_b32 v136, v140
    v_permlane16_swap_b32 v137, v141
    v_permlane16_swap_b32 v138, v142
    v_permlane16_swap_b32 v139, v143
    v_dot2_f32_bf16 v48, v248, s42, v32
    v_dot2_f32_bf16 v49, v248, s43, v33
    v_mfma_f32_32x32x16_bf16 v[16:31], a[108:111], v[132:135], v[16:31]
    v_dot2_f32_bf16 v50, v249, s42, v34
    v_dot2_f32_bf16 v51, v249, s43, v35
    v_dot2_f32_bf16 v52, v250, s42, v36
    v_dot2_f32_bf16 v53, v250, s43, v37
    v_dot2_f32_bf16 v54, v251, s42, v38
    v_dot2_f32_bf16 v55, v251, s43, v39
    v_mfma_f32_32x32x16_bf16 v[16:31], a[120:123], v[136:139], v[16:31]
    s_waitcnt lgkmcnt(0)
    s_barrier
    ds_read_b128 v[80:83], v182 offset:4096
    ds_read_b128 v[84:87], v182 offset:5120
    ds_read_b128 v[64:67], v182 offset:0
    ds_read_b128 v[68:71], v182 offset:1024
    ds_read_b128 v[72:75], v182 offset:2048
    ds_read_b128 v[76:79], v182 offset:3072
    v_mfma_f32_32x32x16_bf16 v[16:31], a[128:131], v[140:143], v[16:31]
    s_cmp_eq_u32 s97, 3
    s_cbranch_scc1 L_m_olast
    s_waitcnt lgkmcnt(4)
    v_pk_add_f32 v[48:49], v[48:49], v[80:81]
    v_pk_add_f32 v[50:51], v[50:51], v[82:83]
    v_pk_add_f32 v[52:53], v[52:53], v[84:85]
    v_pk_add_f32 v[54:55], v[54:55], v[86:87]
    v_cvt_pk_bf16_f32 v248, v48, v49
    v_cvt_pk_bf16_f32 v249, v50, v51
    v_cvt_pk_bf16_f32 v250, v52, v53
    v_cvt_pk_bf16_f32 v251, v54, v55
    buffer_store_dwordx4 v[248:251], v184, s[28:31], s40 offen sc1
    v_dot2_f32_bf16 v188, v248, v248, 0
    v_dot2_f32_bf16 v188, v249, v249, v188
    v_dot2_f32_bf16 v188, v250, v250, v188
    v_dot2_f32_bf16 v188, v251, v251, v188
    s_waitcnt lgkmcnt(2)
    v_pk_add_f32 v[16:17], v[16:17], v[64:65]
    v_pk_add_f32 v[18:19], v[18:19], v[66:67]
    v_pk_add_f32 v[20:21], v[20:21], v[68:69]
    v_pk_add_f32 v[22:23], v[22:23], v[70:71]
    v_cvt_pk_bf16_f32 v240, v16, v17
    v_cvt_pk_bf16_f32 v241, v18, v19
    v_cvt_pk_bf16_f32 v242, v20, v21
    v_cvt_pk_bf16_f32 v243, v22, v23
    buffer_store_dwordx4 v[240:243], v183, s[28:31], s39 offen sc1
    s_waitcnt lgkmcnt(0)
    v_pk_add_f32 v[24:25], v[24:25], v[72:73]
    v_pk_add_f32 v[26:27], v[26:27], v[74:75]
    v_pk_add_f32 v[28:29], v[28:29], v[76:77]
    v_pk_add_f32 v[30:31], v[30:31], v[78:79]
    v_cvt_pk_bf16_f32 v244, v24, v25
    v_cvt_pk_bf16_f32 v245, v26, v27
    v_cvt_pk_bf16_f32 v246, v28, v29
    v_cvt_pk_bf16_f32 v247, v30, v31
    buffer_store_dwordx4 v[244:247], v183, s[28:31], s44 offen sc1
    v_dot2_f32_bf16 v186, v240, v240, 0
    v_dot2_f32_bf16 v187, v244, v244, 0
    v_dot2_f32_bf16 v186, v241, v241, v186
    v_dot2_f32_bf16 v187, v245, v245, v187
    v_dot2_f32_bf16 v186, v242, v242, v186
    v_dot2_f32_bf16 v187, v246, v246, v187
    v_dot2_f32_bf16 v186, v243, v243, v186
    v_dot2_f32_bf16 v187, v247, v247, v187
    s_nop 2
    v_add_f32 v186, v186, v187
    v_and_b32 v188, s25, v188
    v_add_f32 v186, v188, v186
    v_mov_b32 v187, v186
    s_nop 1
    v_permlane32_swap_b32 v187, v186
    v_add_f32_e64 v186, v186, v187
    buffer_store_dword v186, v185, s[28:31], s32 offen sc1
    s_lshl_b32 s60, s96, 4
    s_add_u32 s60, s60, s46
    s_lshl_b32 s60, s60, 4
    s_add_u32 s60, s60, s47
    s_lshl_b32 s60, s60, 5
    s_add_u32 s60, s60, 0x78e000
    s_add_u32 s97, s97, 1
    s_branch L_m_qtop
L_m_olast:
    s_waitcnt lgkmcnt(4)
    v_pk_add_f32 v[48:49], v[48:49], v[80:81]
    v_pk_add_f32 v[50:51], v[50:51], v[82:83]
    v_pk_add_f32 v[52:53], v[52:53], v[84:85]
    v_pk_add_f32 v[54:55], v[54:55], v[86:87]
    v_cvt_pk_bf16_f32 v248, v48, v49
    v_cvt_pk_bf16_f32 v249, v50, v51
    v_cvt_pk_bf16_f32 v250, v52, v53
    v_cvt_pk_bf16_f32 v251, v54, v55
    buffer_store_dwordx4 v[248:251], v184, s[28:31], s40 offen
    v_dot2_f32_bf16 v188, v248, v248, 0
    v_dot2_f32_bf16 v188, v249, v249, v188
    v_dot2_f32_bf16 v188, v250, v250, v188
    v_dot2_f32_bf16 v188, v251, v251, v188
    s_waitcnt lgkmcnt(2)
    v_pk_add_f32 v[16:17], v[16:17], v[64:65]
    v_pk_add_f32 v[18:19], v[18:19], v[66:67]
    v_pk_add_f32 v[20:21], v[20:21], v[68:69]
    v_pk_add_f32 v[22:23], v[22:23], v[70:71]
    v_cvt_pk_bf16_f32 v240, v16, v17
    v_cvt_pk_bf16_f32 v241, v18, v19
    v_cvt_pk_bf16_f32 v242, v20, v21
    v_cvt_pk_bf16_f32 v243, v22, v23
    buffer_store_dwordx4 v[240:243], v183, s[28:31], s39 offen
    s_waitcnt lgkmcnt(0)
    v_pk_add_f32 v[24:25], v[24:25], v[72:73]
    v_pk_add_f32 v[26:27], v[26:27], v[74:75]
    v_pk_add_f32 v[28:29], v[28:29], v[76:77]
    v_pk_add_f32 v[30:31], v[30:31], v[78:79]
    v_cvt_pk_bf16_f32 v244, v24, v25
    v_cvt_pk_bf16_f32 v245, v26, v27
    v_cvt_pk_bf16_f32 v246, v28, v29
    v_cvt_pk_bf16_f32 v247, v30, v31
    buffer_store_dwordx4 v[244:247], v183, s[28:31], s44 offen
    s_or_b32 s6, s2, s3
    s_cbranch_scc1 L_m_odone
    v_mov_b32 v0, s100
    v_mov_b32 v1, s101
    v_mov_b32 v2, 0x7f7f80
    s_mov_b64 exec, 1
    buffer_store_dwordx2 v[0:1], v2, s[56:59], 0 offen
L_m_odone:
    s_waitcnt vmcnt(0)
L_m_end:
    s_endpgm
L_m_psync:
    s_mov_b32 s22, 0x7e0000
    s_mov_b32 s23, 0x40000
    s_waitcnt vmcnt(0)
    s_barrier
    s_cmp_lg_u32 s3, 0
    s_cbranch_scc1 L_m_ppol0
    s_cmp_ge_u32 s2, 200
    s_cselect_b64 exec, 3, 7
    buffer_store_dwordx2 v[254:255], v2, s[56:59], s22 offen sc1
L_m_ppol0:
    s_lshl_b32 exec_lo, 0x01111111, s3
    s_and_b32 exec_lo, exec_lo, 0x03ffffff
    s_lshl_b32 exec_hi, 0x11111000, s3
    .p2align 5
L_m_ppoll:
    buffer_load_dwordx2 v[6:7], v3, s[56:59], s22 offen sc1
    s_sub_u32 s23, s23, 1
    s_cbranch_scc1 L_m_pgot
    s_waitcnt vmcnt(0)
    v_cmp_ne_u64 vcc, s[100:101], v[6:7]
    s_and_b64 exec, vcc, vcc
    s_cbranch_scc1 L_m_ppoll
L_m_pgot:
    s_mov_b64 exec, -1
    s_barrier
    s_add_u32 s20, s19, 0
    s_mov_b32 m0, s20
    s_nop 0
    buffer_load_dwordx4 v253, s[8:11], s20 offen offset:0 sc1 lds
    buffer_load_dwordx4 v253, s[8:11], s20 offen offset:1024 sc1 lds
    buffer_load_dwordx4 v253, s[8:11], s20 offen offset:2048 sc1 lds
    buffer_load_dwordx4 v253, s[8:11], s20 offen offset:3072 sc1 lds
    s_add_u32 s20, s19, 16384
    s_mov_b32 m0, s20
    s_nop 0
    buffer_load_dwordx4 v253, s[8:11], s20 offen offset:0 sc1 lds
    buffer_load_dwordx4 v253, s[8:11], s20 offen offset:1024 sc1 lds
    buffer_load_dwordx4 v253, s[8:11], s20 offen offset:2048 sc1 lds
    buffer_load_dwordx4 v253, s[8:11], s20 offen offset:3072 sc1 lds
    s_add_u32 s20, s19, 32768
    s_mov_b32 m0, s20
    s_nop 0
    buffer_load_dwordx4 v253, s[8:11], s20 offen offset:0 sc1 lds
    buffer_load_dwordx4 v253, s[8:11], s20 offen offset:1024 sc1 lds
    buffer_load_dwordx4 v253, s[8:11], s20 offen offset:2048 sc1 lds
    buffer_load_dwordx4 v253, s[8:11], s20 offen offset:3072 sc1 lds
    s_branch L_m_qgo
L_m_atop:
    s_and_b32 s34, s3, 1
    s_lshr_b32 s35, s3, 1
    s_lshl_b32 s36, s6, 1
    s_add_u32 s36, s36, s34
    s_mul_i32 s17, s36, 163840
    s_mul_i32 s18, s35, 81920
    s_add_u32 s17, s17, s18
    s_add_u32 s17, s17, s62
    s_add_u32 s17, s17, 0x280000
    s_mov_b32 s20, 0
    s_mov_b32 s44, 0xfffff
    s_mov_b32 s45, 0xfffff
    v_lshlrev_b32 v184, 3, v252
    v_and_b32 v194, 31, v252
    v_lshrrev_b32 v196, 5, v252
    v_mad_u32_u24 v185, v196, 20, v194
    v_lshlrev_b32_e64 v185, 4, v185
    v_add_u32 v185, 2560, v185
    s_add_u32 s8, s4, s17
    s_addc_u32 s9, s5, 0
    s_mov_b32 s10, 0x14000
    s_mov_b32 s11, 0x20000
    s_mul_i32 s38, s34, 5120
    s_add_u32 s38, s38, 49152
    v_lshlrev_b32_e64 v195, 3, v194
    s_add_u32 s39, s3, 1
    s_and_b32 s39, s39, 3
    s_mul_i32 s40, s39, 1280
    s_add_u32 s40, s40, s38
    v_add_u32 v204, s40, v253
    v_add_u32_e64 v205, s40, v195
    s_lshl_b32 s39, s39, 2
    s_add_u32 s39, s39, s3
    s_mul_i32 s39, s39, 3072
    v_add_u32 v187, s39, v253
    s_xor_b32 s39, s3, 2
    s_lshl_b32 s40, s3, 2
    s_add_u32 s39, s39, s40
    s_mul_i32 s39, s39, 3072
    v_add_u32_e64 v190, s39, v253
    s_add_u32 s39, s3, 2
    s_and_b32 s39, s39, 3
    s_mul_i32 s40, s39, 1280
    s_add_u32 s40, s40, s38
    v_add_u32 v206, s40, v253
    v_add_u32_e64 v207, s40, v195
    s_lshl_b32 s39, s39, 2
    s_add_u32 s39, s39, s3
    s_mul_i32 s39, s39, 3072
    v_add_u32 v188, s39, v253
    s_xor_b32 s39, s3, 1
    s_lshl_b32 s40, s3, 2
    s_add_u32 s39, s39, s40
    s_mul_i32 s39, s39, 3072
    v_add_u32_e64 v191, s39, v253
    s_add_u32 s39, s3, 3
    s_and_b32 s39, s39, 3
    s_mul_i32 s40, s39, 1280
    s_add_u32 s40, s40, s38
    v_add_u32 v208, s40, v253
    v_add_u32_e64 v209, s40, v195
    s_lshl_b32 s39, s39, 2
    s_add_u32 s39, s39, s3
    s_mul_i32 s39, s39, 3072
    v_add_u32 v189, s39, v253
    s_xor_b32 s39, s3, 3
    s_lshl_b32 s40, s3, 2
    s_add_u32 s39, s39, s40
    s_mul_i32 s39, s39, 3072
    v_add_u32_e64 v192, s39, v253
    s_add_u32 s39, s3, 4
    s_and_b32 s39, s39, 3
    s_mul_i32 s40, s39, 1280
    s_add_u32 s40, s40, s38
    v_add_u32 v210, s40, v253
    v_add_u32 v211, s40, v195
    s_lshl_b32 s22, s96, 4
    s_add_u32 s22, s22, s6
    s_lshl_b32 s22, s22, 2
    s_add_u32 s22, s22, s3
    s_lshl_b32 s22, s22, 7
    s_add_u32 s22, s22, 0x78e000
    v_lshlrev_b32 v197, 5, v252
    s_cmp_lg_u32 s3, 0
    s_waitcnt vmcnt(0)
    s_barrier
    s_cbranch_scc1 L_m_pub2763
    s_mov_b64 exec, 1
    buffer_store_dwordx2 v[254:255], off, s[56:59], s60 sc1
    s_mov_b64 exec, -1
L_m_pub2763:
    s_add_u32 s96, s96, 1
    s_waitcnt lgkmcnt(3)
    v_mfma_f32_32x32x16_bf16 v[0:15], v[64:67], a[132:135], v[0:15]
    ds_read_b128 v[64:67], v253 offset:45056
    s_add_u32 m0, s53, 61440
    s_nop 0
    buffer_load_dwordx4 v253, s[48:51], s53 offen offset:0 sc1 lds
    s_waitcnt lgkmcnt(3)
    v_mfma_f32_32x32x16_bf16 v[0:15], v[68:71], a[136:139], v[0:15]
    ds_read_b128 v[68:71], v253 offset:46080
    s_waitcnt lgkmcnt(3)
    v_mfma_f32_32x32x16_bf16 v[0:15], v[72:75], a[140:143], v[0:15]
    ds_read_b128 v[72:75], v253 offset:47104
    s_waitcnt lgkmcnt(3)
    v_mfma_f32_32x32x16_bf16 v[0:15], v[76:79], a[144:147], v[0:15]
    ds_read_b128 v[76:79], v253 offset:48128
    s_waitcnt lgkmcnt(3)
    v_mfma_f32_32x32x16_bf16 v[0:15], v[64:67], a[148:151], v[0:15]
    s_waitcnt lgkmcnt(2)
    v_mfma_f32_32x32x16_bf16 v[0:15], v[68:71], a[152:155], v[0:15]
    s_waitcnt lgkmcnt(1)
    v_mfma_f32_32x32x16_bf16 v[0:15], v[72:75], a[156:159], v[0:15]
    s_waitcnt lgkmcnt(0)
    v_mfma_f32_32x32x16_bf16 v[0:15], v[76:79], a[160:163], v[0:15]
    s_nop 11
    v_pk_mul_f32 v[0:1], v[0:1], v[156:157] op_sel_hi:[1,0]
    v_pk_mul_f32 v[2:3], v[2:3], v[156:157] op_sel_hi:[1,0]
    v_cvt_pk_bf16_f32 v64, v0, v1
    v_pk_mul_f32 v[4:5], v[4:5], v[156:157] op_sel_hi:[1,0]
    v_cvt_pk_bf16_f32 v65, v2, v3
    v_pk_mul_f32 v[6:7], v[6:7], v[156:157] op_sel_hi:[1,0]
    v_cvt_pk_bf16_f32 v66, v4, v5
    v_pk_mul_f32 v[8:9], v[8:9], v[156:157] op_sel_hi:[1,0]
    v_cvt_pk_bf16_f32 v67, v6, v7
    v_pk_mul_f32 v[10:11], v[10:11], v[156:157] op_sel_hi:[1,0]
    v_cvt_pk_bf16_f32 v68, v8, v9
    v_pk_mul_f32 v[12:13], v[12:13], v[156:157] op_sel_hi:[1,0]
    v_cvt_pk_bf16_f32 v69, v10, v11
    v_pk_mul_f32 v[14:15], v[14:15], v[156:157] op_sel_hi:[1,0]
    v_cvt_pk_bf16_f32 v70, v12, v13
    v_pk_mul_f32 v[16:17], v[16:17], v[156:157] op_sel_hi:[1,0]
    v_cvt_pk_bf16_f32 v71, v14, v15
    v_pk_mul_f32 v[18:19], v[18:19], v[156:157] op_sel_hi:[1,0]
    v_cvt_pk_bf16_f32 v72, v16, v17
    v_cvt_pk_bf16_f32 v73, v18, v19
    ds_write_b128 v164, v[64:67] offset:49152
    ds_write_b128 v164, v[68:71] offset:49664
    ds_write_b64 v165, v[72:73] offset:50176
    s_mul_i32 s28, s16, 40960
    s_mul_i32 s29, s97, 2621440
    s_add_u32 s28, s28, s29
    s_add_u32 s28, s28, 0x1278000
    s_add_u32 s24, s4, s28
    s_addc_u32 s25, s5, 0
    s_mov_b32 s26, 0xa000
    s_mov_b32 s27, 0x20000
    s_lshl_b32 s29, s36, 10
    s_xor_b32 s30, s29, 1024
    s_lshr_b32 s31, s6, 1
    s_add_u32 s31, s31, 32
    s_lshl_b32 s31, s31, 10
    s_and_b32 s32, s6, 1
    s_lshl_b32 s32, s32, 9
    s_add_u32 s31, s31, s32
    v_lshl_add_u32 v186, v196, 30, v253
    v_mov_b64 v[80:81], 0
    v_mov_b64 v[82:83], 0
    v_mov_b64 v[84:85], 0
    v_mov_b64 v[86:87], 0
    v_mov_b64 v[88:89], 0
    v_mov_b64 v[90:91], 0
    v_mov_b64 v[92:93], 0
    v_mov_b64 v[94:95], 0
    v_mov_b64 v[96:97], 0
    v_mov_b64 v[98:99], 0
    v_mov_b64 v[100:101], 0
    v_mov_b64 v[102:103], 0
    v_mov_b64 v[104:105], 0
    v_mov_b64 v[106:107], 0
    v_mov_b64 v[108:109], 0
    v_mov_b64 v[110:111], 0
    v_mov_b64 v[112:113], 0
    v_mov_b64 v[114:115], 0
    v_mov_b64 v[116:117], 0
    v_mov_b64 v[118:119], 0
    v_mov_b64 v[120:121], 0
    v_mov_b64 v[122:123], 0
    v_mov_b64 v[124:125], 0
    v_mov_b64 v[126:127], 0
    v_mov_b64 v[128:129], 0
    v_mov_b64 v[130:131], 0
    v_mov_b64 v[132:133], 0
    v_mov_b64 v[134:135], 0
    v_mov_b64 v[136:137], 0
    v_mov_b64 v[138:139], 0
    v_mov_b64 v[140:141], 0
    v_mov_b64 v[142:143], 0
    v_mov_b64 v[144:145], 0
    v_mov_b64 v[146:147], 0
    v_mov_b64 v[148:149], 0
    v_mov_b64 v[150:151], 0
    v_mov_b64 v[152:153], 0
    v_mov_b64 v[154:155], 0
    v_mov_b64 v[156:157], 0
    v_mov_b64 v[158:159], 0
    v_mov_b64 v[60:61], 0
    v_mov_b64_e64 v[62:63], 0
    s_waitcnt lgkmcnt(0)
    s_mov_b32 s23, 0x40000
    s_mov_b64 exec, 15
    .p2align 5
L_m_poll2884:
    buffer_load_dwordx2 v[198:199], v197, s[56:59], s22 offen sc1
    s_sub_u32 s23, s23, 1
    s_cbranch_scc1 L_m_poll2884x
    s_waitcnt vmcnt(0)
    v_cmp_ne_u64 vcc, s[100:101], v[198:199]
    s_and_b64 exec, vcc, vcc
    s_cbranch_scc1 L_m_poll2884
L_m_poll2884x:
    s_mov_b64 exec, -1
    s_barrier
    buffer_load_dwordx4 a[0:3], v253, s[8:11], s20 offen sc1
    buffer_load_dwordx4 a[4:7], v253, s[8:11], s20 offen offset:1024 sc1
    buffer_load_dwordx2 a[8:9], v184, s[8:11], s20 offen offset:2048 sc1
    s_mov_b64 exec, s[44:45]
    buffer_load_dwordx4 a[10:13], v185, s[8:11], s20 offen offset:0 sc1
    buffer_load_dwordx4 a[14:17], v185, s[8:11], s20 offen offset:640 sc1
    buffer_load_dwordx4 a[18:21], v185, s[8:11], s20 offen offset:1280 sc1
    buffer_load_dwordx4 a[22:25], v185, s[8:11], s20 offen offset:1920 sc1
    s_mov_b64 exec, -1
    s_add_u32 s20, s20, 5120
    buffer_load_dwordx4 a[26:29], v253, s[8:11], s20 offen sc1
    buffer_load_dwordx4 a[30:33], v253, s[8:11], s20 offen offset:1024 sc1
    buffer_load_dwordx2 a[34:35], v184, s[8:11], s20 offen offset:2048 sc1
    ds_read_b128 v[160:163], v204
    ds_read_b64 v[164:165], v205 offset:1024
    ds_read_b128 v[166:169], v206
    ds_read_b64 v[170:171], v207 offset:1024
    ds_read_b128 v[172:175], v208
    ds_read_b64 v[176:177], v209 offset:1024
    ds_read_b128 v[178:181], v210
    ds_read_b64 v[182:183], v211 offset:1024
    s_waitcnt vmcnt(7) lgkmcnt(0)
    v_mfma_f32_32x32x16_bf16 v[0:15], a[0:3], v[160:163], 0
    v_mfma_f32_32x32x16_bf16 v[16:31], a[4:7], v[160:163], 0
    s_nop 9
    v_mfma_f32_32x32x4_2b_bf16 v[0:31], a[8:9], v[164:165], v[0:31]
    s_nop 15
    s_nop 3
    .p2align 6
L_m_aloop:
    v_mfma_f32_32x32x16_bf16 v[32:47], a[0:3], v[166:169], 0
    s_sub_u32 s53, s53, 3072
    s_add_u32 m0, s53, 61440
    v_exp_f32_e64 v0, v0
    v_cvt_pk_bf16_f32 v94, v60, v61
    v_exp_f32 v1, v1
    v_exp_f32 v2, v2
    v_cvt_pk_bf16_f32 v95, v62, v63
    v_mfma_f32_32x32x16_bf16 v[48:63], a[4:7], v[166:169], 0
    buffer_load_dwordx4 v253, s[48:51], s53 offen offset:0 sc1 lds
    v_exp_f32 v3, v3
    v_exp_f32 v4, v4
    v_cvt_pk_bf16_f32 v64, v0, v1
    v_exp_f32 v5, v5
    v_exp_f32 v6, v6
    v_cvt_pk_bf16_f32 v65, v2, v3
    v_exp_f32 v7, v7
    v_exp_f32 v8, v8
    v_cvt_pk_bf16_f32 v66, v4, v5
    v_exp_f32_e64 v9, v9
    v_mfma_f32_32x32x4_2b_bf16 v[32:63], a[8:9], v[170:171], v[32:63]
    v_exp_f32_e64 v10, v10
    v_cvt_pk_bf16_f32 v67, v6, v7
    v_exp_f32 v11, v11
    v_exp_f32 v12, v12
    v_cvt_pk_bf16_f32 v68, v8, v9
    v_exp_f32 v13, v13
    v_exp_f32 v14, v14
    v_cvt_pk_bf16_f32 v69, v10, v11
    v_exp_f32_e64 v15, v15
    v_mfma_f32_32x32x16_bf16 v[144:159], a[36:39], v[80:83], v[144:159]
    buffer_load_dwordx4 v253, s[48:51], s53 offen offset:1024 sc1 lds
    v_exp_f32_e64 v16, v16
    v_cvt_pk_bf16_f32 v70, v12, v13
    v_exp_f32 v17, v17
    v_exp_f32 v18, v18
    v_cvt_pk_bf16_f32 v71, v14, v15
    v_exp_f32_e64 v19, v19
    v_mfma_f32_32x32x16_bf16 v[144:159], a[40:43], v[84:87], v[144:159]
    v_exp_f32_e64 v20, v20
    v_cvt_pk_bf16_f32 v72, v16, v17
    v_exp_f32 v21, v21
    v_exp_f32 v22, v22
    v_cvt_pk_bf16_f32 v73, v18, v19
    v_exp_f32_e64 v23, v23
    v_mfma_f32_32x32x16_bf16 v[144:159], a[44:47], v[88:91], v[144:159]
    buffer_load_dwordx4 v253, s[48:51], s53 offen offset:2048 sc1 lds
    v_exp_f32_e64 v24, v24
    v_cvt_pk_bf16_f32 v74, v20, v21
    v_exp_f32 v25, v25
    v_exp_f32 v26, v26
    v_cvt_pk_bf16_f32 v75, v22, v23
    v_exp_f32_e64 v27, v27
    v_mfma_f32_32x32x16_bf16 v[144:159], a[48:51], v[92:95], v[144:159]
    v_exp_f32_e64 v28, v28
    v_cvt_pk_bf16_f32 v76, v24, v25
    v_exp_f32 v29, v29
    v_exp_f32 v30, v30
    v_cvt_pk_bf16_f32 v77, v26, v27
    v_exp_f32_e64 v31, v31
    v_mfma_f32_32x32x16_bf16 v[0:15], a[0:3], v[172:175], 0
    s_mov_b64 exec, s[44:45]
    buffer_load_dwordx4 a[36:39], v185, s[8:11], s20 offen offset:0 sc1
    buffer_load_dwordx4 a[40:43], v185, s[8:11], s20 offen offset:640 sc1
    buffer_load_dwordx4 a[44:47], v185, s[8:11], s20 offen offset:1280 sc1
    buffer_load_dwordx4 a[48:51], v185, s[8:11], s20 offen offset:1920 sc1
    s_mov_b64 exec, -1
    v_exp_f32_e64 v32, v32
    v_cvt_pk_bf16_f32 v78, v28, v29
    v_exp_f32 v33, v33
    v_exp_f32 v34, v34
    v_cvt_pk_bf16_f32 v79, v30, v31
    v_mfma_f32_32x32x16_bf16 v[16:31], a[4:7], v[172:175], 0
    s_waitcnt vmcnt(10)
    v_exp_f32 v35, v35
    v_exp_f32_e64 v36, v36
    v_cvt_pk_bf16_f32 v80, v32, v33
    v_exp_f32 v37, v37
    v_exp_f32 v38, v38
    v_cvt_pk_bf16_f32 v81, v34, v35
    v_exp_f32 v39, v39
    v_exp_f32 v40, v40
    v_cvt_pk_bf16_f32 v82, v36, v37
    v_exp_f32_e64 v41, v41
    v_mfma_f32_32x32x4_2b_bf16 v[0:31], a[8:9], v[176:177], v[0:31]
    v_exp_f32_e64 v42, v42
    v_cvt_pk_bf16_f32 v83, v38, v39
    v_exp_f32 v43, v43
    v_exp_f32 v44, v44
    v_cvt_pk_bf16_f32 v84, v40, v41
    v_exp_f32 v45, v45
    v_exp_f32 v46, v46
    v_cvt_pk_bf16_f32 v85, v42, v43
    v_exp_f32_e64 v47, v47
    v_mfma_f32_32x32x16_bf16 v[96:111], a[10:13], v[64:67], v[96:111]
    s_add_u32 s20, s20, 5120
    v_exp_f32_e64 v48, v48
    v_cvt_pk_bf16_f32 v86, v44, v45
    v_exp_f32 v49, v49
    v_exp_f32 v50, v50
    v_cvt_pk_bf16_f32 v87, v46, v47
    v_exp_f32_e64 v51, v51
    v_mfma_f32_32x32x16_bf16 v[96:111], a[14:17], v[68:71], v[96:111]
    v_exp_f32_e64 v52, v52
    v_cvt_pk_bf16_f32 v88, v48, v49
    v_exp_f32 v53, v53
    v_exp_f32 v54, v54
    v_cvt_pk_bf16_f32 v89, v50, v51
    v_exp_f32_e64 v55, v55
    v_mfma_f32_32x32x16_bf16 v[96:111], a[18:21], v[72:75], v[96:111]
    v_exp_f32_e64 v56, v56
    v_cvt_pk_bf16_f32 v90, v52, v53
    v_exp_f32 v57, v57
    v_exp_f32 v58, v58
    v_cvt_pk_bf16_f32 v91, v54, v55
    v_exp_f32_e64 v59, v59
    v_mfma_f32_32x32x16_bf16 v[96:111], a[22:25], v[76:79], v[96:111]
    v_exp_f32_e64 v60, v60
    v_cvt_pk_bf16_f32 v92, v56, v57
    v_exp_f32 v61, v61
    v_exp_f32 v62, v62
    v_cvt_pk_bf16_f32 v93, v58, v59
    v_exp_f32_e64 v63, v63
    v_mfma_f32_32x32x16_bf16 v[32:47], a[0:3], v[178:181], 0
    v_exp_f32_e64 v0, v0
    v_cvt_pk_bf16_f32 v94, v60, v61
    v_exp_f32 v1, v1
    v_exp_f32 v2, v2
    v_cvt_pk_bf16_f32 v95, v62, v63
    v_mfma_f32_32x32x16_bf16 v[48:63], a[4:7], v[178:181], 0
    v_exp_f32 v3, v3
    v_exp_f32 v4, v4
    v_cvt_pk_bf16_f32 v64, v0, v1
    v_exp_f32 v5, v5
    v_exp_f32 v6, v6
    v_cvt_pk_bf16_f32 v65, v2, v3
    v_exp_f32 v7, v7
    v_exp_f32 v8, v8
    v_cvt_pk_bf16_f32 v66, v4, v5
    v_exp_f32_e64 v9, v9
    v_mfma_f32_32x32x4_2b_bf16 v[32:63], a[8:9], v[182:183], v[32:63]
    v_exp_f32_e64 v10, v10
    v_cvt_pk_bf16_f32 v67, v6, v7
    v_exp_f32 v11, v11
    v_exp_f32 v12, v12
    v_cvt_pk_bf16_f32 v68, v8, v9
    v_exp_f32 v13, v13
    v_exp_f32 v14, v14
    v_cvt_pk_bf16_f32 v69, v10, v11
    v_exp_f32_e64 v15, v15
    v_mfma_f32_32x32x16_bf16 v[112:127], a[10:13], v[80:83], v[112:127]
    v_exp_f32_e64 v16, v16
    v_cvt_pk_bf16_f32 v70, v12, v13
    v_exp_f32 v17, v17
    v_exp_f32 v18, v18
    v_cvt_pk_bf16_f32 v71, v14, v15
    v_exp_f32_e64 v19, v19
    v_mfma_f32_32x32x16_bf16 v[112:127], a[14:17], v[84:87], v[112:127]
    v_exp_f32_e64 v20, v20
    v_cvt_pk_bf16_f32 v72, v16, v17
    v_exp_f32 v21, v21
    v_exp_f32 v22, v22
    v_cvt_pk_bf16_f32 v73, v18, v19
    v_exp_f32_e64 v23, v23
    v_mfma_f32_32x32x16_bf16 v[112:127], a[18:21], v[88:91], v[112:127]
    v_exp_f32_e64 v24, v24
    v_cvt_pk_bf16_f32 v74, v20, v21
    v_exp_f32 v25, v25
    v_exp_f32 v26, v26
    v_cvt_pk_bf16_f32 v75, v22, v23
    v_exp_f32_e64 v27, v27
    v_mfma_f32_32x32x16_bf16 v[112:127], a[22:25], v[92:95], v[112:127]
    s_waitcnt vmcnt(7)
    v_exp_f32 v28, v28
    v_cvt_pk_bf16_f32 v76, v24, v25
    v_exp_f32 v29, v29
    v_exp_f32 v30, v30
    v_cvt_pk_bf16_f32 v77, v26, v27
    v_exp_f32_e64 v31, v31
    v_mfma_f32_32x32x16_bf16 v[0:15], a[26:29], v[160:163], 0
    buffer_load_dwordx4 a[0:3], v253, s[8:11], s20 offen sc1
    v_exp_f32_e64 v32, v32
    v_cvt_pk_bf16_f32 v78, v28, v29
    v_exp_f32 v33, v33
    v_exp_f32 v34, v34
    v_cvt_pk_bf16_f32 v79, v30, v31
    v_mfma_f32_32x32x16_bf16 v[16:31], a[30:33], v[160:163], 0
    buffer_load_dwordx4 a[4:7], v253, s[8:11], s20 offen offset:1024 sc1
    v_exp_f32 v35, v35
    v_exp_f32 v36, v36
    v_cvt_pk_bf16_f32 v80, v32, v33
    v_exp_f32 v37, v37
    v_exp_f32 v38, v38
    v_cvt_pk_bf16_f32 v81, v34, v35
    v_exp_f32 v39, v39
    v_exp_f32 v40, v40
    v_cvt_pk_bf16_f32 v82, v36, v37
    v_exp_f32_e64 v41, v41
    v_mfma_f32_32x32x4_2b_bf16 v[0:31], a[34:35], v[164:165], v[0:31]
    v_exp_f32_e64 v42, v42
    v_cvt_pk_bf16_f32 v83, v38, v39
    v_exp_f32 v43, v43
    v_exp_f32 v44, v44
    v_cvt_pk_bf16_f32 v84, v40, v41
    v_exp_f32 v45, v45
    v_exp_f32 v46, v46
    v_cvt_pk_bf16_f32 v85, v42, v43
    v_exp_f32_e64 v47, v47
    v_mfma_f32_32x32x16_bf16 v[128:143], a[10:13], v[64:67], v[128:143]
    buffer_load_dwordx2 a[8:9], v184, s[8:11], s20 offen offset:2048 sc1
    v_exp_f32_e64 v48, v48
    v_cvt_pk_bf16_f32 v86, v44, v45
    v_exp_f32 v49, v49
    v_exp_f32 v50, v50
    v_cvt_pk_bf16_f32 v87, v46, v47
    v_exp_f32_e64 v51, v51
    v_mfma_f32_32x32x16_bf16 v[128:143], a[14:17], v[68:71], v[128:143]
    v_exp_f32_e64 v52, v52
    v_cvt_pk_bf16_f32 v88, v48, v49
    v_exp_f32 v53, v53
    v_exp_f32 v54, v54
    v_cvt_pk_bf16_f32 v89, v50, v51
    v_exp_f32_e64 v55, v55
    v_mfma_f32_32x32x16_bf16 v[128:143], a[18:21], v[72:75], v[128:143]
    v_exp_f32_e64 v56, v56
    v_cvt_pk_bf16_f32 v90, v52, v53
    v_exp_f32 v57, v57
    v_exp_f32 v58, v58
    v_cvt_pk_bf16_f32 v91, v54, v55
    v_exp_f32_e64 v59, v59
    v_mfma_f32_32x32x16_bf16 v[128:143], a[22:25], v[76:79], v[128:143]
    v_exp_f32_e64 v60, v60
    v_cvt_pk_bf16_f32 v92, v56, v57
    v_exp_f32 v61, v61
    v_exp_f32 v62, v62
    v_cvt_pk_bf16_f32 v93, v58, v59
    v_exp_f32_e64 v63, v63
    v_mfma_f32_32x32x16_bf16 v[32:47], a[26:29], v[166:169], 0
    v_exp_f32_e64 v0, v0
    v_cvt_pk_bf16_f32 v94, v60, v61
    v_exp_f32 v1, v1
    v_exp_f32 v2, v2
    v_cvt_pk_bf16_f32 v95, v62, v63
    v_mfma_f32_32x32x16_bf16 v[48:63], a[30:33], v[166:169], 0
    v_exp_f32 v3, v3
    v_exp_f32 v4, v4
    v_cvt_pk_bf16_f32 v64, v0, v1
    v_exp_f32 v5, v5
    v_exp_f32 v6, v6
    v_cvt_pk_bf16_f32 v65, v2, v3
    v_exp_f32 v7, v7
    v_exp_f32 v8, v8
    v_cvt_pk_bf16_f32 v66, v4, v5
    v_exp_f32_e64 v9, v9
    v_mfma_f32_32x32x4_2b_bf16 v[32:63], a[34:35], v[170:171], v[32:63]
    v_exp_f32_e64 v10, v10
    v_cvt_pk_bf16_f32 v67, v6, v7
    v_exp_f32 v11, v11
    v_exp_f32 v12, v12
    v_cvt_pk_bf16_f32 v68, v8, v9
    v_exp_f32 v13, v13
    v_exp_f32 v14, v14
    v_cvt_pk_bf16_f32 v69, v10, v11
    v_exp_f32_e64 v15, v15
    v_mfma_f32_32x32x16_bf16 v[144:159], a[10:13], v[80:83], v[144:159]
    v_exp_f32_e64 v16, v16
    v_cvt_pk_bf16_f32 v70, v12, v13
    v_exp_f32 v17, v17
    v_exp_f32 v18, v18
    v_cvt_pk_bf16_f32 v71, v14, v15
    v_exp_f32_e64 v19, v19
    v_mfma_f32_32x32x16_bf16 v[144:159], a[14:17], v[84:87], v[144:159]
    v_exp_f32_e64 v20, v20
    v_cvt_pk_bf16_f32 v72, v16, v17
    v_exp_f32 v21, v21
    v_exp_f32 v22, v22
    v_cvt_pk_bf16_f32 v73, v18, v19
    v_exp_f32_e64 v23, v23
    v_mfma_f32_32x32x16_bf16 v[144:159], a[18:21], v[88:91], v[144:159]
    v_exp_f32_e64 v24, v24
    v_cvt_pk_bf16_f32 v74, v20, v21
    v_exp_f32 v25, v25
    v_exp_f32 v26, v26
    v_cvt_pk_bf16_f32 v75, v22, v23
    v_exp_f32_e64 v27, v27
    v_mfma_f32_32x32x16_bf16 v[144:159], a[22:25], v[92:95], v[144:159]
    v_exp_f32_e64 v28, v28
    v_cvt_pk_bf16_f32 v76, v24, v25
    v_exp_f32 v29, v29
    v_exp_f32 v30, v30
    v_cvt_pk_bf16_f32 v77, v26, v27
    v_exp_f32_e64 v31, v31
    v_mfma_f32_32x32x16_bf16 v[0:15], a[26:29], v[172:175], 0
    s_mov_b64 exec, s[44:45]
    buffer_load_dwordx4 a[10:13], v185, s[8:11], s20 offen offset:0 sc1
    buffer_load_dwordx4 a[14:17], v185, s[8:11], s20 offen offset:640 sc1
    buffer_load_dwordx4 a[18:21], v185, s[8:11], s20 offen offset:1280 sc1
    buffer_load_dwordx4 a[22:25], v185, s[8:11], s20 offen offset:1920 sc1
    s_mov_b64 exec, -1
    v_exp_f32_e64 v32, v32
    v_cvt_pk_bf16_f32 v78, v28, v29
    v_exp_f32 v33, v33
    v_exp_f32 v34, v34
    v_cvt_pk_bf16_f32 v79, v30, v31
    v_mfma_f32_32x32x16_bf16 v[16:31], a[30:33], v[172:175], 0
    s_waitcnt vmcnt(7)
    v_exp_f32 v35, v35
    v_exp_f32_e64 v36, v36
    v_cvt_pk_bf16_f32 v80, v32, v33
    v_exp_f32 v37, v37
    v_exp_f32 v38, v38
    v_cvt_pk_bf16_f32 v81, v34, v35
    v_exp_f32 v39, v39
    v_exp_f32 v40, v40
    v_cvt_pk_bf16_f32 v82, v36, v37
    v_exp_f32_e64 v41, v41
    v_mfma_f32_32x32x4_2b_bf16 v[0:31], a[34:35], v[176:177], v[0:31]
    v_exp_f32_e64 v42, v42
    v_cvt_pk_bf16_f32 v83, v38, v39
    v_exp_f32 v43, v43
    v_exp_f32 v44, v44
    v_cvt_pk_bf16_f32 v84, v40, v41
    v_exp_f32 v45, v45
    v_exp_f32 v46, v46
    v_cvt_pk_bf16_f32 v85, v42, v43
    v_exp_f32_e64 v47, v47
    v_mfma_f32_32x32x16_bf16 v[96:111], a[36:39], v[64:67], v[96:111]
    s_add_u32 s20, s20, 5120
    v_exp_f32_e64 v48, v48
    v_cvt_pk_bf16_f32 v86, v44, v45
    v_exp_f32 v49, v49
    v_exp_f32 v50, v50
    v_cvt_pk_bf16_f32 v87, v46, v47
    v_exp_f32_e64 v51, v51
    v_mfma_f32_32x32x16_bf16 v[96:111], a[40:43], v[68:71], v[96:111]
    s_cmp_eq_u32 s20, 87040
    v_exp_f32_e64 v52, v52
    v_cvt_pk_bf16_f32 v88, v48, v49
    v_exp_f32 v53, v53
    v_exp_f32 v54, v54
    v_cvt_pk_bf16_f32 v89, v50, v51
    v_exp_f32_e64 v55, v55
    v_mfma_f32_32x32x16_bf16 v[96:111], a[44:47], v[72:75], v[96:111]
    v_exp_f32_e64 v56, v56
    v_cvt_pk_bf16_f32 v90, v52, v53
    v_exp_f32 v57, v57
    v_exp_f32 v58, v58
    v_cvt_pk_bf16_f32 v91, v54, v55
    v_exp_f32_e64 v59, v59
    v_mfma_f32_32x32x16_bf16 v[96:111], a[48:51], v[76:79], v[96:111]
    v_exp_f32_e64 v60, v60
    v_cvt_pk_bf16_f32 v92, v56, v57
    v_exp_f32 v61, v61
    v_exp_f32 v62, v62
    v_cvt_pk_bf16_f32 v93, v58, v59
    v_exp_f32 v63, v63
    s_cbranch_scc1 L_m_atail
    v_mfma_f32_32x32x16_bf16 v[32:47], a[26:29], v[178:181], 0
    v_exp_f32_e64 v0, v0
    v_cvt_pk_bf16_f32 v94, v60, v61
    v_exp_f32 v1, v1
    v_exp_f32 v2, v2
    v_cvt_pk_bf16_f32 v95, v62, v63
    v_mfma_f32_32x32x16_bf16 v[48:63], a[30:33], v[178:181], 0
    v_exp_f32 v3, v3
    v_exp_f32 v4, v4
    v_cvt_pk_bf16_f32 v64, v0, v1
    v_exp_f32 v5, v5
    v_exp_f32 v6, v6
    v_cvt_pk_bf16_f32 v65, v2, v3
    v_exp_f32 v7, v7
    v_exp_f32 v8, v8
    v_cvt_pk_bf16_f32 v66, v4, v5
    v_exp_f32_e64 v9, v9
    v_mfma_f32_32x32x4_2b_bf16 v[32:63], a[34:35], v[182:183], v[32:63]
    v_exp_f32_e64 v10, v10
    v_cvt_pk_bf16_f32 v67, v6, v7
    v_exp_f32 v11, v11
    v_exp_f32 v12, v12
    v_cvt_pk_bf16_f32 v68, v8, v9
    v_exp_f32 v13, v13
    v_exp_f32 v14, v14
    v_cvt_pk_bf16_f32 v69, v10, v11
    v_exp_f32_e64 v15, v15
    v_mfma_f32_32x32x16_bf16 v[112:127], a[36:39], v[80:83], v[112:127]
    v_exp_f32_e64 v16, v16
    v_cvt_pk_bf16_f32 v70, v12, v13
    v_exp_f32 v17, v17
    v_exp_f32 v18, v18
    v_cvt_pk_bf16_f32 v71, v14, v15
    v_exp_f32_e64 v19, v19
    v_mfma_f32_32x32x16_bf16 v[112:127], a[40:43], v[84:87], v[112:127]
    v_exp_f32_e64 v20, v20
    v_cvt_pk_bf16_f32 v72, v16, v17
    v_exp_f32 v21, v21
    v_exp_f32 v22, v22
    v_cvt_pk_bf16_f32 v73, v18, v19
    v_exp_f32_e64 v23, v23
    v_mfma_f32_32x32x16_bf16 v[112:127], a[44:47], v[88:91], v[112:127]
    v_exp_f32_e64 v24, v24
    v_cvt_pk_bf16_f32 v74, v20, v21
    v_exp_f32 v25, v25
    v_exp_f32 v26, v26
    v_cvt_pk_bf16_f32 v75, v22, v23
    v_exp_f32_e64 v27, v27
    v_mfma_f32_32x32x16_bf16 v[112:127], a[48:51], v[92:95], v[112:127]
    s_waitcnt vmcnt(4)
    v_exp_f32 v28, v28
    v_cvt_pk_bf16_f32 v76, v24, v25
    v_exp_f32 v29, v29
    v_exp_f32 v30, v30
    v_cvt_pk_bf16_f32 v77, v26, v27
    v_exp_f32_e64 v31, v31
    v_mfma_f32_32x32x16_bf16 v[0:15], a[0:3], v[160:163], 0
    buffer_load_dwordx4 a[26:29], v253, s[8:11], s20 offen sc1
    v_exp_f32_e64 v32, v32
    v_cvt_pk_bf16_f32 v78, v28, v29
    v_exp_f32 v33, v33
    v_exp_f32 v34, v34
    v_cvt_pk_bf16_f32 v79, v30, v31
    v_mfma_f32_32x32x16_bf16 v[16:31], a[4:7], v[160:163], 0
    buffer_load_dwordx4 a[30:33], v253, s[8:11], s20 offen offset:1024 sc1
    v_exp_f32 v35, v35
    v_exp_f32 v36, v36
    v_cvt_pk_bf16_f32 v80, v32, v33
    v_exp_f32 v37, v37
    v_exp_f32 v38, v38
    v_cvt_pk_bf16_f32 v81, v34, v35
    v_exp_f32 v39, v39
    v_exp_f32 v40, v40
    v_cvt_pk_bf16_f32 v82, v36, v37
    v_exp_f32_e64 v41, v41
    v_mfma_f32_32x32x4_2b_bf16 v[0:31], a[8:9], v[164:165], v[0:31]
    v_exp_f32_e64 v42, v42
    v_cvt_pk_bf16_f32 v83, v38, v39
    v_exp_f32 v43, v43
    v_exp_f32 v44, v44
    v_cvt_pk_bf16_f32 v84, v40, v41
    v_exp_f32 v45, v45
    v_exp_f32 v46, v46
    v_cvt_pk_bf16_f32 v85, v42, v43
    v_exp_f32_e64 v47, v47
    v_mfma_f32_32x32x16_bf16 v[128:143], a[36:39], v[64:67], v[128:143]
    buffer_load_dwordx2 a[34:35], v184, s[8:11], s20 offen offset:2048 sc1
    v_exp_f32_e64 v48, v48
    v_cvt_pk_bf16_f32 v86, v44, v45
    v_exp_f32 v49, v49
    v_exp_f32 v50, v50
    v_cvt_pk_bf16_f32 v87, v46, v47
    v_exp_f32_e64 v51, v51
    v_mfma_f32_32x32x16_bf16 v[128:143], a[40:43], v[68:71], v[128:143]
    v_exp_f32_e64 v52, v52
    v_cvt_pk_bf16_f32 v88, v48, v49
    v_exp_f32 v53, v53
    v_exp_f32 v54, v54
    v_cvt_pk_bf16_f32 v89, v50, v51
    v_exp_f32_e64 v55, v55
    v_mfma_f32_32x32x16_bf16 v[128:143], a[44:47], v[72:75], v[128:143]
    v_exp_f32_e64 v56, v56
    v_cvt_pk_bf16_f32 v90, v52, v53
    v_exp_f32 v57, v57
    v_exp_f32 v58, v58
    v_cvt_pk_bf16_f32 v91, v54, v55
    v_exp_f32_e64 v59, v59
    v_mfma_f32_32x32x16_bf16 v[128:143], a[48:51], v[76:79], v[128:143]
    v_exp_f32_e64 v60, v60
    v_cvt_pk_bf16_f32 v92, v56, v57
    v_exp_f32 v61, v61
    v_exp_f32 v62, v62
    v_cvt_pk_bf16_f32 v93, v58, v59
    v_exp_f32 v63, v63
    s_branch L_m_aloop
    .p2align 3
L_m_atail:
    v_mfma_f32_32x32x16_bf16 v[32:47], a[26:29], v[178:181], 0
    v_exp_f32_e64 v0, v0
    v_cvt_pk_bf16_f32 v94, v60, v61
    v_exp_f32 v1, v1
    v_exp_f32 v2, v2
    v_cvt_pk_bf16_f32 v95, v62, v63
    v_mfma_f32_32x32x16_bf16 v[48:63], a[30:33], v[178:181], 0
    v_exp_f32 v3, v3
    v_exp_f32 v4, v4
    v_cvt_pk_bf16_f32 v64, v0, v1
    v_exp_f32 v5, v5
    v_exp_f32 v6, v6
    v_cvt_pk_bf16_f32 v65, v2, v3
    v_exp_f32 v7, v7
    v_exp_f32 v8, v8
    v_cvt_pk_bf16_f32 v66, v4, v5
    v_exp_f32_e64 v9, v9
    v_mfma_f32_32x32x4_2b_bf16 v[32:63], a[34:35], v[182:183], v[32:63]
    ds_write_b128 v187, v[96:99] offset:0
    v_exp_f32_e64 v10, v10
    v_cvt_pk_bf16_f32 v67, v6, v7
    v_exp_f32 v11, v11
    v_exp_f32 v12, v12
    v_cvt_pk_bf16_f32 v68, v8, v9
    v_exp_f32 v13, v13
    v_exp_f32 v14, v14
    v_cvt_pk_bf16_f32 v69, v10, v11
    v_exp_f32_e64 v15, v15
    v_mfma_f32_32x32x16_bf16 v[112:127], a[36:39], v[80:83], v[112:127]
    ds_write_b128 v187, v[100:103] offset:1024
    v_exp_f32_e64 v16, v16
    v_cvt_pk_bf16_f32 v70, v12, v13
    v_exp_f32 v17, v17
    v_exp_f32 v18, v18
    v_cvt_pk_bf16_f32 v71, v14, v15
    v_exp_f32_e64 v19, v19
    v_mfma_f32_32x32x16_bf16 v[112:127], a[40:43], v[84:87], v[112:127]
    ds_write_b128 v187, v[104:107] offset:2048
    v_exp_f32_e64 v20, v20
    v_cvt_pk_bf16_f32 v72, v16, v17
    v_exp_f32 v21, v21
    v_exp_f32 v22, v22
    v_cvt_pk_bf16_f32 v73, v18, v19
    v_exp_f32_e64 v23, v23
    v_mfma_f32_32x32x16_bf16 v[112:127], a[44:47], v[88:91], v[112:127]
    v_exp_f32_e64 v24, v24
    v_cvt_pk_bf16_f32 v74, v20, v21
    v_exp_f32 v25, v25
    v_exp_f32 v26, v26
    v_cvt_pk_bf16_f32 v75, v22, v23
    v_exp_f32_e64 v27, v27
    v_mfma_f32_32x32x16_bf16 v[112:127], a[48:51], v[92:95], v[112:127]
    v_exp_f32_e64 v28, v28
    v_cvt_pk_bf16_f32 v76, v24, v25
    v_exp_f32 v29, v29
    v_exp_f32 v30, v30
    v_cvt_pk_bf16_f32 v77, v26, v27
    v_exp_f32 v31, v31
    v_exp_f32 v32, v32
    v_cvt_pk_bf16_f32 v78, v28, v29
    v_exp_f32 v33, v33
    v_exp_f32 v34, v34
    v_cvt_pk_bf16_f32 v79, v30, v31
    v_exp_f32 v35, v35
    v_exp_f32 v36, v36
    v_cvt_pk_bf16_f32 v80, v32, v33
    v_exp_f32 v37, v37
    v_exp_f32 v38, v38
    v_cvt_pk_bf16_f32 v81, v34, v35
    v_exp_f32 v39, v39
    v_exp_f32 v40, v40
    v_cvt_pk_bf16_f32 v82, v36, v37
    v_exp_f32_e64 v41, v41
    ds_write_b128 v188, v[112:115] offset:0
    v_exp_f32_e64 v42, v42
    v_cvt_pk_bf16_f32 v83, v38, v39
    v_exp_f32 v43, v43
    v_exp_f32 v44, v44
    v_cvt_pk_bf16_f32 v84, v40, v41
    v_exp_f32 v45, v45
    v_exp_f32 v46, v46
    v_cvt_pk_bf16_f32 v85, v42, v43
    v_exp_f32_e64 v47, v47
    v_mfma_f32_32x32x16_bf16 v[128:143], a[36:39], v[64:67], v[128:143]
    ds_write_b128 v188, v[116:119] offset:1024
    v_exp_f32_e64 v48, v48
    v_cvt_pk_bf16_f32 v86, v44, v45
    v_exp_f32 v49, v49
    v_exp_f32 v50, v50
    v_cvt_pk_bf16_f32 v87, v46, v47
    v_exp_f32_e64 v51, v51
    v_mfma_f32_32x32x16_bf16 v[128:143], a[40:43], v[68:71], v[128:143]
    ds_write_b128 v188, v[120:123] offset:2048
    v_exp_f32_e64 v52, v52
    v_cvt_pk_bf16_f32 v88, v48, v49
    v_exp_f32 v53, v53
    v_exp_f32 v54, v54
    v_cvt_pk_bf16_f32 v89, v50, v51
    v_exp_f32_e64 v55, v55
    v_mfma_f32_32x32x16_bf16 v[128:143], a[44:47], v[72:75], v[128:143]
    v_exp_f32_e64 v56, v56
    v_cvt_pk_bf16_f32 v90, v52, v53
    v_exp_f32 v57, v57
    v_exp_f32 v58, v58
    v_cvt_pk_bf16_f32 v91, v54, v55
    v_exp_f32_e64 v59, v59
    v_mfma_f32_32x32x16_bf16 v[128:143], a[48:51], v[76:79], v[128:143]
    v_exp_f32_e64 v60, v60
    v_cvt_pk_bf16_f32 v92, v56, v57
    v_exp_f32 v61, v61
    v_exp_f32 v62, v62
    v_cvt_pk_bf16_f32 v93, v58, v59
    v_exp_f32_e64 v63, v63
    v_mfma_f32_32x32x16_bf16 v[144:159], a[36:39], v[80:83], v[144:159]
    v_cvt_pk_bf16_f32 v94, v60, v61
    v_cvt_pk_bf16_f32 v95, v62, v63
    v_mfma_f32_32x32x16_bf16 v[144:159], a[40:43], v[84:87], v[144:159]
    s_nop 1
    ds_write_b128 v189, v[128:131] offset:0
    v_mfma_f32_32x32x16_bf16 v[144:159], a[44:47], v[88:91], v[144:159]
    ds_write_b128 v189, v[132:135] offset:1024
    v_mfma_f32_32x32x16_bf16 v[144:159], a[48:51], v[92:95], v[144:159]
    ds_write_b128 v189, v[136:139] offset:2048
    s_waitcnt lgkmcnt(0)
    s_barrier
    ds_read_b128 v[96:99], v190 offset:0
    ds_read_b128 v[100:103], v190 offset:1024
    ds_read_b128 v[104:107], v190 offset:2048
    ds_read_b128 v[112:115], v191 offset:0
    ds_read_b128 v[116:119], v191 offset:1024
    ds_read_b128 v[120:123], v191 offset:2048
    ds_read_b128 v[128:131], v192 offset:0
    ds_read_b128 v[132:135], v192 offset:1024
    ds_read_b128 v[136:139], v192 offset:2048
    s_mov_b32 s46, 0
    s_cmp_eq_u32 s34, 1
    s_cselect_b64 s[40:41], -1, 0
    s_waitcnt lgkmcnt(6)
    v_pk_add_f32 v[152:153], v[152:153], v[104:105]
    v_pk_add_f32 v[144:145], v[144:145], v[96:97]
    v_pk_add_f32 v[146:147], v[146:147], v[98:99]
    v_pk_add_f32 v[148:149], v[148:149], v[100:101]
    v_pk_add_f32 v[150:151], v[150:151], v[102:103]
    v_pk_add_f32 v[154:155], v[154:155], v[106:107]
    s_waitcnt lgkmcnt(0)
    v_pk_add_f32 v[120:121], v[120:121], v[136:137]
    v_pk_add_f32 v[112:113], v[112:113], v[128:129]
    v_pk_add_f32 v[114:115], v[114:115], v[130:131]
    v_pk_add_f32 v[116:117], v[116:117], v[132:133]
    v_pk_add_f32 v[118:119], v[118:119], v[134:135]
    v_pk_add_f32 v[122:123], v[122:123], v[138:139]
L_m_afin:
    v_mov_b32 v194, v152
    v_mov_b32 v195, v152
    s_nop 1
    v_permlane32_swap_b32 v194, v195
    v_rcp_f32 v196, v195
    s_nop 0
    v_pk_mul_f32 v[0:1], v[144:145], v[196:197] op_sel_hi:[1,0]
    v_pk_mul_f32 v[2:3], v[146:147], v[196:197] op_sel_hi:[1,0]
    v_pk_mul_f32 v[4:5], v[148:149], v[196:197] op_sel_hi:[1,0]
    v_pk_mul_f32 v[6:7], v[150:151], v[196:197] op_sel_hi:[1,0]
    v_pk_mul_f32 v[8:9], v[152:153], v[196:197] op_sel_hi:[1,0]
    v_pk_mul_f32 v[10:11], v[154:155], v[196:197] op_sel_hi:[1,0]
    v_cvt_pk_bf16_f32 v64, v0, v1
    v_cvt_pk_bf16_f32 v65, v2, v3
    v_cvt_pk_bf16_f32 v66, v4, v5
    v_cvt_pk_bf16_f32 v67, v6, v7
    v_cvt_pk_bf16_f32 v68, v8, v9
    v_cvt_pk_bf16_f32 v69, v10, v11
    buffer_store_dwordx4 v[64:67], v253, s[24:27], s29 offen sc1
    v_mov_b32 v198, v120
    v_mov_b32 v199, v120
    s_nop 1
    v_permlane32_swap_b32 v198, v199
    v_rcp_f32 v200, v199
    s_nop 0
    v_pk_mul_f32 v[16:17], v[112:113], v[200:201] op_sel_hi:[1,0]
    v_pk_mul_f32 v[18:19], v[114:115], v[200:201] op_sel_hi:[1,0]
    v_pk_mul_f32 v[20:21], v[116:117], v[200:201] op_sel_hi:[1,0]
    v_pk_mul_f32 v[22:23], v[118:119], v[200:201] op_sel_hi:[1,0]
    v_pk_mul_f32 v[24:25], v[120:121], v[200:201] op_sel_hi:[1,0]
    v_pk_mul_f32 v[26:27], v[122:123], v[200:201] op_sel_hi:[1,0]
    v_cvt_pk_bf16_f32 v70, v16, v17
    v_cvt_pk_bf16_f32 v71, v18, v19
    v_cvt_pk_bf16_f32 v72, v20, v21
    v_cvt_pk_bf16_f32 v73, v22, v23
    v_cvt_pk_bf16_f32 v74, v24, v25
    v_cvt_pk_bf16_f32 v75, v26, v27
    buffer_store_dwordx4 v[70:73], v253, s[24:27], s30 offen sc1
    v_cndmask_b32 v76, v68, v74, s[40:41]
    v_cndmask_b32 v78, v74, v68, s[40:41]
    v_cndmask_b32 v77, v69, v75, s[40:41]
    v_cndmask_b32 v79, v75, v69, s[40:41]
    buffer_store_dwordx4 v[76:79], v186, s[24:27], s31 offen sc1
    v_pk_add_f32 v[144:145], v[144:145], v[112:113]
    v_pk_add_f32 v[146:147], v[146:147], v[114:115]
    v_pk_add_f32 v[148:149], v[148:149], v[116:117]
    v_pk_add_f32 v[150:151], v[150:151], v[118:119]
    v_pk_add_f32 v[152:153], v[152:153], v[120:121]
    v_pk_add_f32 v[154:155], v[154:155], v[122:123]
    v_pk_add_f32 v[144:145], v[144:145], v[150:151]
    v_pk_add_f32 v[146:147], v[146:147], v[152:153]
    v_pk_add_f32 v[148:149], v[148:149], v[154:155]
    v_min_f32_e64 v194, v195, v199
    v_pk_add_f32 v[144:145], v[144:145], v[146:147]
    v_cmp_gt_f32 vcc, 0x12800000, v194
    v_pk_add_f32 v[144:145], v[144:145], v[148:149]
    v_mov_b32 v194, 0x207
    v_add_f32_e64 v144, v144, v145
    v_cmp_class_f32 s[42:43], v144, v194
    s_cmp_lg_u32 s46, 0
    s_cbranch_scc1 L_m_aok
    s_or_b64 vcc, vcc, s[42:43]
    s_cbranch_scc1 L_m_aslow
L_m_aok:
    s_lshl_b32 s60, s96, 4
    s_add_u32 s60, s60, s7
    s_lshl_b32 s60, s60, 4
    s_add_u32 s60, s60, s6
    s_lshl_b32 s60, s60, 5
    s_add_u32 s60, s60, 0x78e000
    s_branch L_m_otop
L_m_aslow:
    s_waitcnt vmcnt(0)
    v_accvgpr_read_b32 v96, a10
    v_accvgpr_read_b32 v97, a11
    v_accvgpr_read_b32 v98, a12
    v_accvgpr_read_b32 v99, a13
    v_accvgpr_read_b32 v100, a14
    v_accvgpr_read_b32 v101, a15
    v_accvgpr_read_b32 v102, a16
    v_accvgpr_read_b32 v103, a17
    v_accvgpr_read_b32 v104, a18
    v_accvgpr_read_b32 v105, a19
    v_accvgpr_read_b32 v106, a20
    v_accvgpr_read_b32 v107, a21
    v_accvgpr_read_b32 v108, a22
    v_accvgpr_read_b32 v109, a23
    v_accvgpr_read_b32 v110, a24
    v_accvgpr_read_b32 v111, a25
L_m_aslow0:
    s_xor_b32 s36, s36, 1
    s_mul_i32 s17, s36, 163840
    s_add_u32 s17, s17, s62
    s_add_u32 s17, s17, 0x280000
    s_add_u32 s12, s4, s17
    s_addc_u32 s13, s5, 0
    s_mov_b32 s14, 0x28000
    s_mov_b32 s15, 0x20000
    s_and_b32 s39, s36, 1
    s_lshl_b32 s39, s39, 2
    s_add_u32 s39, s39, s3
    s_mul_i32 s39, s39, 1280
    s_add_u32 s39, s39, 49152
    v_and_b32 v195, 255, v184
    v_add_u32 v194, s39, v253
    v_add_u32 v195, s39, v195
    ds_read_b128 v[160:163], v194
    ds_read_b64 v[164:165], v195 offset:1024
    s_mov_b32 s20, 0
    s_waitcnt lgkmcnt(0)
    v_mov_b32 v194, 0xff800000
L_m_aslow1:
    buffer_load_dwordx4 v[220:223], v253, s[12:15], s20 offen sc1
    buffer_load_dwordx4 v[224:227], v253, s[12:15], s20 offen offset:1024 sc1
    buffer_load_dwordx2 v[228:229], v184, s[12:15], s20 offen offset:2048 sc1
    s_waitcnt vmcnt(0)
    v_mfma_f32_32x32x16_bf16 v[0:15], v[220:223], v[160:163], 0
    v_mfma_f32_32x32x16_bf16 v[16:31], v[224:227], v[160:163], 0
    s_nop 9
    v_mfma_f32_32x32x4_2b_bf16 v[0:31], v[228:229], v[164:165], v[0:31]
    s_nop 15
    s_nop 3
    v_max3_f32 v194, v0, v1, v194
    v_max3_f32 v194, v2, v3, v194
    v_max3_f32 v194, v4, v5, v194
    v_max3_f32 v194, v6, v7, v194
    v_max3_f32 v194, v8, v9, v194
    v_max3_f32 v194, v10, v11, v194
    v_max3_f32 v194, v12, v13, v194
    v_max3_f32 v194, v14, v15, v194
    v_max3_f32 v194, v16, v17, v194
    v_max3_f32 v194, v18, v19, v194
    v_max3_f32 v194, v20, v21, v194
    v_max3_f32 v194, v22, v23, v194
    v_max3_f32 v194, v24, v25, v194
    v_max3_f32 v194, v26, v27, v194
    v_max3_f32 v194, v28, v29, v194
    v_max3_f32 v194, v30, v31, v194
    s_add_u32 s20, s20, 5120
    s_cmp_lg_u32 s20, 163840
    s_cbranch_scc1 L_m_aslow1
    s_mov_b32 s20, 0
    v_mov_b32 v195, v194
    s_nop 1
    v_permlane32_swap_b32 v195, v194
    v_max_f32 v194, v194, v195
    v_sub_f32 v204, 0, v194
    v_mov_b32 v112, v144
    v_mov_b32 v144, 0
    v_sub_f32 v205, 0, v194
    v_mov_b32 v113, v145
    v_mov_b32 v145, 0
    v_sub_f32 v206, 0, v194
    v_mov_b32 v114, v146
    v_mov_b32 v146, 0
    v_sub_f32 v207, 0, v194
    v_mov_b32 v115, v147
    v_mov_b32 v147, 0
    v_sub_f32 v208, 0, v194
    v_mov_b32 v116, v148
    v_mov_b32 v148, 0
    v_sub_f32 v209, 0, v194
    v_mov_b32 v117, v149
    v_mov_b32 v149, 0
    v_sub_f32 v210, 0, v194
    v_mov_b32 v118, v150
    v_mov_b32 v150, 0
    v_sub_f32 v211, 0, v194
    v_mov_b32 v119, v151
    v_mov_b32 v151, 0
    v_sub_f32 v212, 0, v194
    v_mov_b32 v120, v152
    v_mov_b32 v152, 0
    v_sub_f32 v213, 0, v194
    v_mov_b32 v121, v153
    v_mov_b32 v153, 0
    v_sub_f32 v214, 0, v194
    v_mov_b32 v122, v154
    v_mov_b32 v154, 0
    v_sub_f32 v215, 0, v194
    v_mov_b32 v123, v155
    v_mov_b32 v155, 0
    v_sub_f32 v216, 0, v194
    v_mov_b32 v124, v156
    v_mov_b32 v156, 0
    v_sub_f32 v217, 0, v194
    v_mov_b32 v125, v157
    v_mov_b32 v157, 0
    v_sub_f32 v218, 0, v194
    v_mov_b32 v126, v158
    v_mov_b32 v158, 0
    v_sub_f32 v219, 0, v194
    v_mov_b32 v127, v159
    v_mov_b32 v159, 0
L_m_aslow2:
    buffer_load_dwordx4 v[220:223], v253, s[12:15], s20 offen sc1
    buffer_load_dwordx4 v[224:227], v253, s[12:15], s20 offen offset:1024 sc1
    buffer_load_dwordx2 v[228:229], v184, s[12:15], s20 offen offset:2048 sc1
    s_mov_b64 exec, s[44:45]
    buffer_load_dwordx4 v[96:99], v185, s[12:15], s20 offen offset:0 sc1
    buffer_load_dwordx4 v[100:103], v185, s[12:15], s20 offen offset:640 sc1
    buffer_load_dwordx4 v[104:107], v185, s[12:15], s20 offen offset:1280 sc1
    buffer_load_dwordx4 v[108:111], v185, s[12:15], s20 offen offset:1920 sc1
    s_mov_b64 exec, -1
    s_waitcnt vmcnt(0)
    v_mfma_f32_32x32x16_bf16 v[0:15], v[220:223], v[160:163], v[204:219]
    v_mfma_f32_32x32x16_bf16 v[16:31], v[224:227], v[160:163], v[204:219]
    s_nop 9
    v_mfma_f32_32x32x4_2b_bf16 v[0:31], v[228:229], v[164:165], v[0:31]
    s_nop 15
    s_nop 3
    v_exp_f32 v0, v0
    v_exp_f32 v1, v1
    v_exp_f32 v2, v2
    v_exp_f32 v3, v3
    v_exp_f32 v4, v4
    v_exp_f32 v5, v5
    v_exp_f32 v6, v6
    v_exp_f32 v7, v7
    v_exp_f32 v8, v8
    v_exp_f32 v9, v9
    v_exp_f32 v10, v10
    v_exp_f32 v11, v11
    v_exp_f32 v12, v12
    v_exp_f32 v13, v13
    v_exp_f32 v14, v14
    v_exp_f32 v15, v15
    v_exp_f32 v16, v16
    v_exp_f32 v17, v17
    v_exp_f32 v18, v18
    v_exp_f32 v19, v19
    v_exp_f32 v20, v20
    v_exp_f32 v21, v21
    v_exp_f32 v22, v22
    v_exp_f32 v23, v23
    v_exp_f32 v24, v24
    v_exp_f32 v25, v25
    v_exp_f32 v26, v26
    v_exp_f32 v27, v27
    v_exp_f32 v28, v28
    v_exp_f32 v29, v29
    v_exp_f32 v30, v30
    v_exp_f32 v31, v31
    v_cvt_pk_bf16_f32 v64, v0, v1
    v_cvt_pk_bf16_f32 v65, v2, v3
    v_cvt_pk_bf16_f32 v66, v4, v5
    v_cvt_pk_bf16_f32 v67, v6, v7
    v_cvt_pk_bf16_f32 v68, v8, v9
    v_cvt_pk_bf16_f32 v69, v10, v11
    v_cvt_pk_bf16_f32 v70, v12, v13
    v_cvt_pk_bf16_f32 v71, v14, v15
    v_cvt_pk_bf16_f32 v72, v16, v17
    v_cvt_pk_bf16_f32 v73, v18, v19
    v_cvt_pk_bf16_f32 v74, v20, v21
    v_cvt_pk_bf16_f32 v75, v22, v23
    v_cvt_pk_bf16_f32 v76, v24, v25
    v_cvt_pk_bf16_f32 v77, v26, v27
    v_cvt_pk_bf16_f32 v78, v28, v29
    v_cvt_pk_bf16_f32 v79, v30, v31
    v_mfma_f32_32x32x16_bf16 v[144:159], v[96:99], v[64:67], v[144:159]
    v_mfma_f32_32x32x16_bf16 v[144:159], v[100:103], v[68:71], v[144:159]
    v_mfma_f32_32x32x16_bf16 v[144:159], v[104:107], v[72:75], v[144:159]
    v_mfma_f32_32x32x16_bf16 v[144:159], v[108:111], v[76:79], v[144:159]
    s_add_u32 s20, s20, 5120
    s_cmp_lg_u32 s20, 163840
    s_nop 15
    s_cbranch_scc1 L_m_aslow2
    s_add_u32 s46, s46, 1
    s_cmp_eq_u32 s46, 1
    s_cbranch_scc1 L_m_aslow0
    s_branch L_m_afin
L_m_last:

.section .rodata,"a"
.p2align 6
.amdhsa_kernel interleave_layers__linear_attn_block__softmax_full_mha__prompt_kernel
  .amdhsa_next_free_vgpr 420
  .amdhsa_next_free_sgpr 102
  .amdhsa_accum_offset 256
  .amdhsa_group_segment_fixed_size 0
  .amdhsa_kernarg_size 72
  .amdhsa_user_sgpr_count 2
  .amdhsa_user_sgpr_kernarg_segment_ptr 1
  .amdhsa_system_sgpr_workgroup_id_x 1
.end_amdhsa_kernel
```
